```python
import torch

def _softmax(x, axis=-1):
    return torch.softmax(x, dim=axis)
def _gelu(x):
    return torch.nn.functional.gelu(x, approximate="tanh")
def _silu(x):
    return torch.nn.functional.silu(x)
def _sigmoid(x):
    return torch.sigmoid(x)
def _layernorm(x, axis=-1, eps=1e-5):
    m = x.mean(dim=axis, keepdim=True)
    v = x.var(dim=axis, keepdim=True, unbiased=False)
    return (x - m) / torch.sqrt(v + eps)
def _scatter_add(tgt, idx, src, axis=0):
    return tgt.clone().index_add_(axis, idx, src)
def _segment_sum(src, seg, n):
    out = torch.zeros((n,) + src.shape[1:], dtype=src.dtype)
    return out.index_add_(0, seg, src)
def _pad(x, pw):
    flat = tuple(v for pair in reversed(pw) for v in pair)
    return torch.nn.functional.pad(x, flat)

kernel_name = 'recurrent_scan__softmax_full_mha__glu_gated_swiglu__prompt'

def setup_inputs():

    _w = (lambda a: (lambda t: t.to(torch.bfloat16) if t.is_floating_point() else t)(torch.as_tensor(a)))
    def _A_setup():
        B, S, D = 1, 2048, 512
        return {
            "x": _w((lambda *s: torch.randn(*s, dtype=torch.bfloat16) * 0.05)(B, S, D)),
            "wqkv": _w((lambda *s: torch.randn(*s, dtype=torch.bfloat16) * 0.2)(D, 3 * D)),
            "wo": _w((lambda *s: torch.randn(*s, dtype=torch.bfloat16) * 0.2)(D, D)),
        }
    _A_in = _A_setup()

    def _B_setup():
        B, S, D, F = 1, 2048, 512, 1792
        return {
            "x": _w((lambda *s: torch.randn(*s, dtype=torch.bfloat16) * 0.05)(B, S, D)),
            "w1": _w((lambda *s: torch.randn(*s, dtype=torch.bfloat16) * 0.1)(D, F) * (2.0 / D) ** 0.5),
            "w3": _w((lambda *s: torch.randn(*s, dtype=torch.bfloat16) * 0.1)(D, F) * (2.0 / D) ** 0.5),
            "w2": _w((lambda *s: torch.randn(*s, dtype=torch.bfloat16) * 0.1)(F, D) * (2.0 / F) ** 0.5),
        }
    _B_in = _B_setup()

    return {
        "A_x": _A_in["x"],
        "A_wqkv": _A_in["wqkv"],
        "A_wo": _A_in["wo"],
        "B_x": _B_in["x"],
        "B_w1": _B_in["w1"],
        "B_w3": _B_in["w3"],
        "B_w2": _B_in["w2"],
    }

def reference(A_x, A_wqkv, A_wo, B_x, B_w1, B_w3, B_w2):
    def _A_ref(x, wqkv, wo):
        B, S, D = x.shape
        H = 32; Dh = D // H
        qkv = (lambda x, *d: x.permute(*d))((x @ wqkv).reshape(B, S, 3, H, Dh), 2, 0, 3, 1, 4)
        q, k, v = qkv[0], qkv[1], qkv[2]
        scale = Dh ** -0.5
        scores = torch.einsum("bhqd,bhkd->bhqk", q, k) * scale
        p = _softmax(scores, axis=-1)
        o = torch.einsum("bhqk,bhkd->bhqd", p, v)
        return (lambda x, *d: x.permute(*d))(o, 0, 2, 1, 3).reshape(B, S, D) @ wo

    def _B_ref(x, w1, w3, w2):
        gate = torch.einsum("bsd,df->bsf", x, w1)
        up = torch.einsum("bsd,df->bsf", x, w3)
        h = _silu(gate) * up
        out = torch.einsum("bsf,fd->bsd", h, w2)
        return out

    x = A_x
    xn = _layernorm(x, axis=-1)
    s = _A_ref(xn, A_wqkv, A_wo)
    g = _silu(_B_ref(xn, B_w1, B_w3, B_w2))
    return x + s * g
```

```asm
; @launch grid=(256,1,1) block=(512,1,1) lds=163840
.amdgcn_target "amdgcn-amd-amdhsa--gfx950"
.text
.globl recurrent_scan__softmax_full_mha__glu_gated_swiglu__prompt_kernel
.p2align 8
.type recurrent_scan__softmax_full_mha__glu_gated_swiglu__prompt_kernel,@function
recurrent_scan__softmax_full_mha__glu_gated_swiglu__prompt_kernel:
    s_cmp_ge_u32 s2, 0x100
    s_cbranch_scc1 L_exit
    s_load_dwordx16 s[4:19], s[0:1], 0
    s_load_dwordx4 s[20:23], s[0:1], 64
    v_lshrrev_b32 v1, 6, v0
    v_and_b32 v0, 63, v0
    v_readfirstlane_b32 s56, v1
    s_and_b32 s64, s2, 7
    s_bfe_u32 s60, s2, 0x30003
    s_lshr_b32 s65, s2, 6
    s_lshl_b32 s66, s64, 2
    s_add_u32 s59, s66, s65
    s_and_b32 s67, s64, 3
    s_and_b32 s68, s60, 3
    s_lshl_b32 s66, s67, 2
    s_add_u32 s57, s66, s68
    s_lshr_b32 s66, s64, 2
    s_lshl_b32 s66, s66, 3
    s_lshr_b32 s65, s2, 5
    s_add_u32 s58, s66, s65
    s_add_u32 s64, s68, s58
    s_and_b32 s64, s64, 1
    s_lshl_b32 s70, s64, 2
    s_cmp_ge_u32 s56, 4
    s_cbranch_scc0 L_first0
    s_mov_b32 s30, 0x180000
    s_mov_b32 s31, 0x20000
    s_and_b32 s66, s56, 3
    s_mul_i32 s71, s66, 0xc00
    s_mul_i32 s66, s66, 0xc000
    s_lshr_b32 s64, s58, 1
    s_lshl_b32 s64, s64, 7
    s_add_u32 s69, s64, s66
    s_and_b32 s65, s58, 1
    s_lshl_b32 s64, s65, 10
    s_add_u32 s64, s64, s69
    s_lshl_b32 s65, s65, 6
    s_add_u32 s65, s65, 0x780
    s_add_u32 s65, s65, s69
    v_mov_b32 v19, s64
    v_mov_b32 v20, s65
    s_mov_b32 s66, 0xaaab
    v_add_u32 v16, 0, v0
    v_mul_u32_u24 v17, s66, v16
    v_lshrrev_b32 v17, 19, v17
    v_mul_u32_u24 v18, 12, v17
    v_sub_u32 v16, v16, v18
    v_cmp_le_u32 vcc, 8, v16
    v_mul_u32_u24 v17, 0xc00, v17
    v_lshl_add_u32 v17, v16, 4, v17
    v_cndmask_b32 v18, v19, v20, vcc
    v_add_u32 v24, v18, v17
    v_add_u32 v16, 64, v0
    v_mul_u32_u24 v17, s66, v16
    v_lshrrev_b32 v17, 19, v17
    v_mul_u32_u24 v18, 12, v17
    v_sub_u32 v16, v16, v18
    v_cmp_le_u32 vcc, 8, v16
    v_mul_u32_u24 v17, 0xc00, v17
    v_lshl_add_u32 v17, v16, 4, v17
    v_cndmask_b32 v18, v19, v20, vcc
    v_add_u32 v25, v18, v17
    v_add_u32 v16, 0x80, v0
    v_mul_u32_u24 v17, s66, v16
    v_lshrrev_b32 v17, 19, v17
    v_mul_u32_u24 v18, 12, v17
    v_sub_u32 v16, v16, v18
    v_cmp_le_u32 vcc, 8, v16
    v_mul_u32_u24 v17, 0xc00, v17
    v_lshl_add_u32 v17, v16, 4, v17
    v_cndmask_b32 v18, v19, v20, vcc
    v_add_u32 v26, v18, v17
    s_mov_b32 s26, 0x200000
    s_mov_b32 s27, 0x20000
    s_waitcnt lgkmcnt(0)
    s_mov_b32 s24, s4
    s_mov_b32 s25, s5
    s_mov_b32 s28, s6
    s_mov_b32 s29, s7
    s_mov_b32 s20, s70
    s_add_u32 m0, s71, 0x10000
    s_add_u32 s78, s20, 0
    s_and_b32 s78, s78, 7
    s_mul_i32 s78, s78, 0x30000
    buffer_load_dwordx4 v24, s[28:31], s78 offen lds
    s_add_u32 m0, s71, 0x10400
    s_nop 0
    buffer_load_dwordx4 v25, s[28:31], s78 offen lds
    s_add_u32 m0, s71, 0x10800
    s_nop 0
    buffer_load_dwordx4 v26, s[28:31], s78 offen lds
    s_getpc_b64 s[80:81]
L_pc_1:
    s_and_b32 s64, s2, 0xf8
    s_add_u32 s64, s64, s56
    s_lshl_b32 s64, s64, 7
    s_sub_u32 s64, s64, L_pc_1-recurrent_scan__softmax_full_mha__glu_gated_swiglu__prompt_kernel
    s_ashr_i32 s65, s64, 31
    s_add_u32 s80, s80, s64
    s_addc_u32 s81, s81, s65
    s_load_dword s79, s[80:81], 0
    s_load_dword s79, s[80:81], 64
    s_cmp_ge_i32 s64, L_code_end-L_pc_1-32768-128
    s_cbranch_scc1 L_ct_2
    s_load_dword s79, s[80:81], 32768
    s_load_dword s79, s[80:81], 32832
L_ct_2:
    s_branch L_hf1
L_first0:
    v_lshrrev_b32 v4, 3, v0
    v_lshrrev_b32 v5, 4, v0
    v_and_b32 v6, 7, v0
    v_xor_b32 v5, v5, v6
    v_lshlrev_b32 v5, 4, v5
    v_lshl_add_u32 v2, v4, 10, v5
    v_add_u32 v4, 0x2000, v2
    v_xor_b32 v3, 64, v4
    s_lshl_b32 s64, s57, 17
    s_lshl_b32 s65, s56, 15
    s_add_u32 s72, s64, s65
    s_lshl_b32 s73, s56, 12
    s_mov_b32 s26, 0x200000
    s_mov_b32 s27, 0x20000
    s_waitcnt lgkmcnt(0)
    s_mov_b32 s24, s4
    s_mov_b32 s25, s5
    s_mov_b32 s20, s70
    s_add_u32 m0, s73, 0
    s_add_u32 s78, s20, 0
    s_and_b32 s78, s78, 7
    s_lshl_b32 s78, s78, 7
    s_add_u32 s78, s78, s72
    buffer_load_dwordx4 v2, s[24:27], s78 offen lds
    s_add_u32 m0, s73, 0x400
    s_nop 0
    buffer_load_dwordx4 v3, s[24:27], s78 offen lds
    s_add_u32 m0, s73, 0x800
    s_add_u32 s78, s78, 0x4000
    buffer_load_dwordx4 v2, s[24:27], s78 offen lds
    s_add_u32 m0, s73, 0xc00
    s_nop 0
    buffer_load_dwordx4 v3, s[24:27], s78 offen lds
    s_getpc_b64 s[80:81]
L_pc_3:
    s_and_b32 s64, s2, 0xf8
    s_add_u32 s64, s64, s56
    s_lshl_b32 s64, s64, 7
    s_sub_u32 s64, s64, L_pc_3-recurrent_scan__softmax_full_mha__glu_gated_swiglu__prompt_kernel
    s_ashr_i32 s65, s64, 31
    s_add_u32 s80, s80, s64
    s_addc_u32 s81, s81, s65
    s_load_dword s79, s[80:81], 0
    s_load_dword s79, s[80:81], 64
    s_cmp_ge_i32 s64, L_code_end-L_pc_3-32768-128
    s_cbranch_scc1 L_ct_4
    s_load_dword s79, s[80:81], 32768
    s_load_dword s79, s[80:81], 32832
L_ct_4:
    v_bfe_u32 v60, v0, 4, 1
    v_lshrrev_b32 v61, 5, v0
    v_bfe_u32 v62, v0, 2, 2
    v_and_b32 v63, 3, v0
    v_and_b32 v28, 31, v0
    v_bfe_u32 v29, v0, 1, 3
    v_xor_b32 v29, v29, v61
    v_lshlrev_b32 v29, 4, v29
    v_lshl_add_u32 v28, v28, 7, v29
    s_and_b32 s64, s56, 3
    s_lshl_b32 s64, s64, 12
    v_add_u32 v13, s64, v28
    v_xor_b32 v14, 32, v13
    v_xor_b32 v15, 64, v13
    v_xor_b32 v1, 0x60, v13
    v_lshl_add_u32 v28, v61, 3, v62
    v_mul_u32_u24 v29, 0xc0, v28
    v_lshl_add_u32 v29, v60, 5, v29
    v_lshl_add_u32 v29, v63, 3, v29
    v_add_u32 v4, 0x10000, v29
    v_add_u32 v5, 0x1c000, v29
    v_lshlrev_b32 v28, 8, v28
    v_lshl_add_u32 v28, v60, 12, v28
    v_lshl_add_u32 v28, v63, 3, v28
    v_lshl_add_u32 v29, v60, 2, v62
    v_lshl_add_u32 v6, v29, 5, v28
    s_mov_b32 s62, 0x3f803f80
    s_add_u32 m0, s73, 0x4000
    s_add_u32 s78, s20, 1
    s_and_b32 s78, s78, 7
    s_lshl_b32 s78, s78, 7
    s_add_u32 s78, s78, s72
    buffer_load_dwordx4 v2, s[24:27], s78 offen lds
    s_add_u32 m0, s73, 0x4400
    s_nop 0
    buffer_load_dwordx4 v3, s[24:27], s78 offen lds
    s_add_u32 m0, s73, 0x4800
    s_add_u32 s78, s78, 0x4000
    buffer_load_dwordx4 v2, s[24:27], s78 offen lds
    s_add_u32 m0, s73, 0x4c00
    s_nop 0
    buffer_load_dwordx4 v3, s[24:27], s78 offen lds
    s_add_u32 m0, s73, 0x8000
    s_add_u32 s78, s20, 2
    s_and_b32 s78, s78, 7
    s_lshl_b32 s78, s78, 7
    s_add_u32 s78, s78, s72
    buffer_load_dwordx4 v2, s[24:27], s78 offen lds
    s_add_u32 m0, s73, 0x8400
    s_nop 0
    buffer_load_dwordx4 v3, s[24:27], s78 offen lds
    s_add_u32 m0, s73, 0x8800
    s_add_u32 s78, s78, 0x4000
    buffer_load_dwordx4 v2, s[24:27], s78 offen lds
    s_add_u32 m0, s73, 0x8c00
    s_nop 0
    buffer_load_dwordx4 v3, s[24:27], s78 offen lds
    v_mov_b32 v27, s62
    v_mov_b32 v16, 0
    v_mov_b32 v17, 0
    v_mov_b32 v18, 0
    v_mov_b32 v19, 0
    s_and_b32 s68, s56, 3
    s_mov_b32 s36, s12
    s_mov_b32 s37, s13
    s_mov_b32 s38, 0x1c0000
    s_mov_b32 s39, 0x20000
    s_mov_b32 s40, s14
    s_mov_b32 s41, s15
    s_mov_b32 s42, 0x1c0000
    s_mov_b32 s43, 0x20000
    s_mov_b32 s84, s12
    s_mov_b32 s85, s13
    s_mov_b32 s86, 0x1c0000
    s_mov_b32 s87, 0x20000
    s_mov_b32 s52, s22
    s_mov_b32 s53, s23
    s_mov_b32 s54, 0xfa0000
    s_mov_b32 s55, 0x20000
    s_lshl_b32 s75, s56, 10
    s_lshl_b32 s74, s20, 2
    s_waitcnt lgkmcnt(0)
    s_waitcnt vmcnt(8)
    s_barrier
    ds_read_b128 v[128:131], v13 offset:0
    ds_read_b64_tr_b16 v[32:33], v4 offset:0
    ds_read_b64_tr_b16 v[34:35], v4 offset:768
    ds_read_b64_tr_b16 v[36:37], v4 offset:64
    ds_read_b64_tr_b16 v[38:39], v4 offset:832
    ds_read_b128 v[132:135], v14 offset:0
    ds_read_b64_tr_b16 v[40:41], v4 offset:3072
    ds_read_b64_tr_b16 v[42:43], v4 offset:3840
    ds_read_b64_tr_b16 v[44:45], v4 offset:3136
    ds_read_b64_tr_b16 v[46:47], v4 offset:3904
    ds_read_b128 v[136:139], v15 offset:0
    ds_read_b64_tr_b16 v[48:49], v4 offset:6144
    ds_read_b64_tr_b16 v[50:51], v4 offset:6912
    ds_read_b64_tr_b16 v[52:53], v4 offset:6208
    ds_read_b64_tr_b16 v[54:55], v4 offset:6976
    ds_read_b128 v[140:143], v1 offset:0
    ds_read_b64_tr_b16 v[56:57], v4 offset:9216
    ds_read_b64_tr_b16 v[58:59], v4 offset:9984
    ds_read_b64_tr_b16 v[60:61], v4 offset:9280
    ds_read_b64_tr_b16 v[62:63], v4 offset:10048
    s_add_u32 m0, s73, 0xc000
    s_add_u32 s78, s20, 3
    s_and_b32 s78, s78, 7
    s_lshl_b32 s78, s78, 7
    s_add_u32 s78, s78, s72
    buffer_load_dwordx4 v2, s[24:27], s78 offen lds
    s_add_u32 m0, s73, 0xc400
    s_nop 0
    buffer_load_dwordx4 v3, s[24:27], s78 offen lds
    s_add_u32 m0, s73, 0xc800
    s_add_u32 s78, s78, 0x4000
    buffer_load_dwordx4 v2, s[24:27], s78 offen lds
    s_add_u32 m0, s73, 0xcc00
    s_nop 0
    buffer_load_dwordx4 v3, s[24:27], s78 offen lds
    s_waitcnt lgkmcnt(15)
    v_mfma_f32_32x32x16_bf16 v[64:79], v[32:35], v[128:131], 0
    v_mfma_f32_32x32x16_bf16 v[80:95], v[36:39], v[128:131], 0
    s_waitcnt lgkmcnt(12)
    v_mfma_f32_32x32x16_bf16 v[64:79], v[40:43], v[132:135], v[64:79]
    s_waitcnt lgkmcnt(10)
    v_mfma_f32_32x32x16_bf16 v[80:95], v[44:47], v[132:135], v[80:95]
    v_lshrrev_b32 v28, 4, v0
    v_lshlrev_b32 v29, 1, v28
    v_and_b32 v21, 15, v0
    v_xor_b32 v29, v29, v21
    v_mul_u32_u24 v28, 0xe00, v28
    v_lshl_add_u32 v28, v29, 4, v28
    s_and_b32 s64, s56, 3
    s_mul_i32 s64, s64, 0x3800
    s_lshr_b32 s65, s58, 3
    s_sub_u32 s11, s58, s65
    s_and_b32 s65, s58, 7
    s_cmp_eq_u32 s65, 7
    s_cselect_b32 s11, 14, s11
    s_lshl_b32 s65, s11, 8
    s_add_u32 s64, s64, s65
    v_add_u32 v12, s64, v28
    s_cmp_ge_u32 s11, 14
    s_cbranch_scc1 L_idle_5
    s_branch L_done_6
L_idle_5:
    s_lshl_b32 s64, s57, 1
    s_lshr_b32 s65, s58, 3
    s_add_u32 s21, s64, s65
    v_lshrrev_b32 v28, 3, v0
    v_mul_u32_u24 v28, 0xe00, v28
    v_and_b32 v29, 7, v0
    v_lshl_add_u32 v28, v29, 4, v28
    s_and_b32 s64, s56, 3
    s_mul_i32 s64, s64, 0x70000
    s_lshl_b32 s65, s21, 7
    s_add_u32 s64, s64, s65
    s_cmp_ge_u32 s21, 28
    s_cselect_b32 s65, 0x40000000, 0
    s_add_u32 s64, s64, s65
    v_add_u32 v12, s64, v28
L_done_6:
    s_waitcnt lgkmcnt(7)
    v_mfma_f32_32x32x16_bf16 v[64:79], v[48:51], v[136:139], v[64:79]
    s_waitcnt lgkmcnt(5)
    v_mfma_f32_32x32x16_bf16 v[80:95], v[52:55], v[136:139], v[80:95]
    s_waitcnt lgkmcnt(2)
    v_mfma_f32_32x32x16_bf16 v[64:79], v[56:59], v[140:143], v[64:79]
    s_waitcnt lgkmcnt(0)
    v_mfma_f32_32x32x16_bf16 v[80:95], v[60:63], v[140:143], v[80:95]
    s_set_gpr_idx_on s68, gpr_idx(SRC0)
    v_dot2c_f32_bf16 v16, v32, v27
    v_dot2c_f32_bf16 v18, v36, v27
    v_dot2c_f32_bf16 v17, v40, v27
    v_dot2c_f32_bf16 v19, v44, v27
    v_dot2c_f32_bf16 v16, v48, v27
    v_dot2c_f32_bf16 v18, v52, v27
    v_dot2c_f32_bf16 v17, v56, v27
    v_dot2c_f32_bf16 v19, v60, v27
    s_set_gpr_idx_off
    s_waitcnt vmcnt(8)
    s_barrier
    ds_read_b128 v[144:147], v13 offset:16384
    ds_read_b64_tr_b16 v[96:97], v4 offset:12288
    ds_read_b64_tr_b16 v[98:99], v4 offset:13056
    ds_read_b64_tr_b16 v[100:101], v4 offset:12352
    ds_read_b64_tr_b16 v[102:103], v4 offset:13120
    ds_read_b128 v[148:151], v14 offset:16384
    ds_read_b64_tr_b16 v[104:105], v4 offset:15360
    ds_read_b64_tr_b16 v[106:107], v4 offset:16128
    ds_read_b64_tr_b16 v[108:109], v4 offset:15424
    ds_read_b64_tr_b16 v[110:111], v4 offset:16192
    ds_read_b128 v[152:155], v15 offset:16384
    ds_read_b64_tr_b16 v[112:113], v4 offset:18432
    ds_read_b64_tr_b16 v[114:115], v4 offset:19200
    ds_read_b64_tr_b16 v[116:117], v4 offset:18496
    ds_read_b64_tr_b16 v[118:119], v4 offset:19264
    ds_read_b128 v[156:159], v1 offset:16384
    ds_read_b64_tr_b16 v[120:121], v4 offset:21504
    ds_read_b64_tr_b16 v[122:123], v4 offset:22272
    ds_read_b64_tr_b16 v[124:125], v4 offset:21568
    ds_read_b64_tr_b16 v[126:127], v4 offset:22336
    s_waitcnt vmcnt(4)
    s_waitcnt lgkmcnt(0)
    s_barrier
    v_mfma_f32_32x32x16_bf16 v[64:79], v[96:99], v[144:147], v[64:79]
    ds_read_b128 v[160:163], v13 offset:32768
    ds_read_b64_tr_b16 v[32:33], v4 offset:24576
    ds_read_b64_tr_b16 v[34:35], v4 offset:25344
    v_mfma_f32_32x32x16_bf16 v[80:95], v[100:103], v[144:147], v[80:95]
    ds_read_b64_tr_b16 v[36:37], v4 offset:24640
    ds_read_b64_tr_b16 v[38:39], v4 offset:25408
    ds_read_b128 v[164:167], v14 offset:32768
    v_mfma_f32_32x32x16_bf16 v[64:79], v[104:107], v[148:151], v[64:79]
    ds_read_b64_tr_b16 v[40:41], v4 offset:27648
    ds_read_b64_tr_b16 v[42:43], v4 offset:28416
    ds_read_b64_tr_b16 v[44:45], v4 offset:27712
    ds_read_b64_tr_b16 v[46:47], v4 offset:28480
    v_mfma_f32_32x32x16_bf16 v[80:95], v[108:111], v[148:151], v[80:95]
    ds_read_b128 v[168:171], v15 offset:32768
    ds_read_b64_tr_b16 v[48:49], v4 offset:30720
    ds_read_b64_tr_b16 v[50:51], v4 offset:31488
    v_xor_b32 v7, 32, v6
    v_xor_b32 v8, 64, v6
    v_xor_b32 v9, 0x60, v6
    s_mov_b32 s61, 0xffff0000
    s_mov_b32 s83, 0x3f80
    s_mov_b32 s3, 0x3f800000
    s_mul_i32 s76, s56, 0x420
    s_and_b32 s82, s58, 1
    v_cmp_gt_u32 vcc, 32, v0
    v_lshlrev_b32 v10, 4, v0
    s_nop 0
    v_cndmask_b32 v22, 0, -1, vcc
    v_mfma_f32_32x32x16_bf16 v[64:79], v[112:115], v[152:155], v[64:79]
    ds_read_b64_tr_b16 v[52:53], v4 offset:30784
    ds_read_b64_tr_b16 v[54:55], v4 offset:31552
    ds_read_b128 v[172:175], v1 offset:32768
    v_mfma_f32_32x32x16_bf16 v[80:95], v[116:119], v[152:155], v[80:95]
    ds_read_b64_tr_b16 v[56:57], v4 offset:33792
    ds_read_b64_tr_b16 v[58:59], v4 offset:34560
    ds_read_b64_tr_b16 v[60:61], v4 offset:33856
    ds_read_b64_tr_b16 v[62:63], v4 offset:34624
    v_mfma_f32_32x32x16_bf16 v[64:79], v[120:123], v[156:159], v[64:79]
    v_mfma_f32_32x32x16_bf16 v[80:95], v[124:127], v[156:159], v[80:95]
    s_set_gpr_idx_on s68, gpr_idx(SRC0)
    v_dot2c_f32_bf16 v16, v96, v27
    v_dot2c_f32_bf16 v18, v100, v27
    v_dot2c_f32_bf16 v17, v104, v27
    v_dot2c_f32_bf16 v19, v108, v27
    v_dot2c_f32_bf16 v16, v112, v27
    v_dot2c_f32_bf16 v18, v116, v27
    v_dot2c_f32_bf16 v17, v120, v27
    v_dot2c_f32_bf16 v19, v124, v27
    s_set_gpr_idx_off
    s_add_u32 m0, s73, 0
    s_add_u32 s78, s20, 4
    s_and_b32 s78, s78, 7
    s_lshl_b32 s78, s78, 7
    s_add_u32 s78, s78, s72
    buffer_load_dwordx4 v2, s[24:27], s78 offen lds
    s_add_u32 m0, s73, 0x400
    s_nop 0
    buffer_load_dwordx4 v3, s[24:27], s78 offen lds
    s_add_u32 m0, s73, 0x800
    s_add_u32 s78, s78, 0x4000
    buffer_load_dwordx4 v2, s[24:27], s78 offen lds
    s_add_u32 m0, s73, 0xc00
    s_nop 0
    buffer_load_dwordx4 v3, s[24:27], s78 offen lds
    s_add_u32 m0, s73, 0x4000
    s_add_u32 s78, s20, 5
    s_and_b32 s78, s78, 7
    s_lshl_b32 s78, s78, 7
    s_add_u32 s78, s78, s72
    buffer_load_dwordx4 v2, s[24:27], s78 offen lds
    s_add_u32 m0, s73, 0x4400
    s_nop 0
    buffer_load_dwordx4 v3, s[24:27], s78 offen lds
    s_add_u32 m0, s73, 0x4800
    s_add_u32 s78, s78, 0x4000
    buffer_load_dwordx4 v2, s[24:27], s78 offen lds
    s_add_u32 m0, s73, 0x4c00
    s_nop 0
    buffer_load_dwordx4 v3, s[24:27], s78 offen lds
    s_waitcnt vmcnt(8)
    s_waitcnt lgkmcnt(0)
    s_barrier
    v_mfma_f32_32x32x16_bf16 v[64:79], v[32:35], v[160:163], v[64:79]
    ds_read_b128 v[176:179], v13 offset:49152
    ds_read_b64_tr_b16 v[96:97], v4 offset:36864
    ds_read_b64_tr_b16 v[98:99], v4 offset:37632
    v_mfma_f32_32x32x16_bf16 v[80:95], v[36:39], v[160:163], v[80:95]
    ds_read_b64_tr_b16 v[100:101], v4 offset:36928
    ds_read_b64_tr_b16 v[102:103], v4 offset:37696
    ds_read_b128 v[180:183], v14 offset:49152
    v_mfma_f32_32x32x16_bf16 v[64:79], v[40:43], v[164:167], v[64:79]
    ds_read_b64_tr_b16 v[104:105], v4 offset:39936
    ds_read_b64_tr_b16 v[106:107], v4 offset:40704
    ds_read_b64_tr_b16 v[108:109], v4 offset:40000
    ds_read_b64_tr_b16 v[110:111], v4 offset:40768
    v_mfma_f32_32x32x16_bf16 v[80:95], v[44:47], v[164:167], v[80:95]
    ds_read_b128 v[184:187], v15 offset:49152
    ds_read_b64_tr_b16 v[112:113], v4 offset:43008
    ds_read_b64_tr_b16 v[114:115], v4 offset:43776
    v_and_b32 v28, 51, v0
    v_bfe_u32 v29, v0, 2, 1
    v_lshl_add_u32 v28, v29, 3, v28
    v_bfe_u32 v29, v0, 3, 1
    v_lshl_add_u32 v28, v29, 2, v28
    v_lshlrev_b32 v28, 4, v28
    s_cmp_eq_u32 s82, 0
    s_cselect_b64 vcc, -1, 0
    v_cndmask_b32 v11, v28, v10, vcc
    v_mfma_f32_32x32x16_bf16 v[64:79], v[48:51], v[168:171], v[64:79]
    ds_read_b64_tr_b16 v[116:117], v4 offset:43072
    ds_read_b64_tr_b16 v[118:119], v4 offset:43840
    ds_read_b128 v[188:191], v1 offset:49152
    v_mfma_f32_32x32x16_bf16 v[80:95], v[52:55], v[168:171], v[80:95]
    ds_read_b64_tr_b16 v[120:121], v4 offset:46080
    ds_read_b64_tr_b16 v[122:123], v4 offset:46848
    ds_read_b64_tr_b16 v[124:125], v4 offset:46144
    ds_read_b64_tr_b16 v[126:127], v4 offset:46912
    v_mfma_f32_32x32x16_bf16 v[64:79], v[56:59], v[172:175], v[64:79]
    v_mfma_f32_32x32x16_bf16 v[80:95], v[60:63], v[172:175], v[80:95]
    s_set_gpr_idx_on s68, gpr_idx(SRC0)
    v_dot2c_f32_bf16 v16, v32, v27
    v_dot2c_f32_bf16 v18, v36, v27
    v_dot2c_f32_bf16 v17, v40, v27
    v_dot2c_f32_bf16 v19, v44, v27
    v_dot2c_f32_bf16 v16, v48, v27
    v_dot2c_f32_bf16 v18, v52, v27
    v_dot2c_f32_bf16 v17, v56, v27
    v_dot2c_f32_bf16 v19, v60, v27
    s_set_gpr_idx_off
    s_add_u32 m0, s73, 0x8000
    s_add_u32 s78, s20, 6
    s_and_b32 s78, s78, 7
    s_lshl_b32 s78, s78, 7
    s_add_u32 s78, s78, s72
    buffer_load_dwordx4 v2, s[24:27], s78 offen lds
    s_add_u32 m0, s73, 0x8400
    s_nop 0
    buffer_load_dwordx4 v3, s[24:27], s78 offen lds
    s_add_u32 m0, s73, 0x8800
    s_add_u32 s78, s78, 0x4000
    buffer_load_dwordx4 v2, s[24:27], s78 offen lds
    s_add_u32 m0, s73, 0x8c00
    s_nop 0
    buffer_load_dwordx4 v3, s[24:27], s78 offen lds
    s_waitcnt vmcnt(8)
    s_waitcnt lgkmcnt(0)
    s_barrier
    v_mfma_f32_32x32x16_bf16 v[64:79], v[96:99], v[176:179], v[64:79]
    ds_read_b128 v[192:195], v13 offset:0
    ds_read_b64_tr_b16 v[32:33], v5 offset:0
    ds_read_b64_tr_b16 v[34:35], v5 offset:768
    v_mfma_f32_32x32x16_bf16 v[80:95], v[100:103], v[176:179], v[80:95]
    ds_read_b64_tr_b16 v[36:37], v5 offset:64
    ds_read_b64_tr_b16 v[38:39], v5 offset:832
    ds_read_b128 v[196:199], v14 offset:0
    v_mfma_f32_32x32x16_bf16 v[64:79], v[104:107], v[180:183], v[64:79]
    ds_read_b64_tr_b16 v[40:41], v5 offset:3072
    ds_read_b64_tr_b16 v[42:43], v5 offset:3840
    ds_read_b64_tr_b16 v[44:45], v5 offset:3136
    ds_read_b64_tr_b16 v[46:47], v5 offset:3904
    v_mfma_f32_32x32x16_bf16 v[80:95], v[108:111], v[180:183], v[80:95]
    ds_read_b128 v[200:203], v15 offset:0
    ds_read_b64_tr_b16 v[48:49], v5 offset:6144
    ds_read_b64_tr_b16 v[50:51], v5 offset:6912
    s_mov_b32 s44, s16
    s_mov_b32 s45, s17
    s_mov_b32 s46, 0x1c0000
    s_mov_b32 s47, 0x20000
    s_mov_b32 s32, s8
    s_mov_b32 s33, s9
    s_mov_b32 s34, 0x80000
    s_mov_b32 s35, 0x20000
    s_mov_b32 s48, s18
    s_mov_b32 s49, s19
    s_mov_b32 s50, 0x200000
    s_mov_b32 s51, 0x20000
    s_and_b32 s64, s59, 3
    s_mul_i32 s64, s64, 7
    s_lshr_b32 s65, s59, 2
    s_min_u32 s65, s65, 6
    s_add_u32 s10, s64, s65
    s_lshl_b32 s64, s59, 16
    s_add_u32 s77, s64, s75
    v_mfma_f32_32x32x16_bf16 v[64:79], v[112:115], v[184:187], v[64:79]
    ds_read_b64_tr_b16 v[52:53], v5 offset:6208
    ds_read_b64_tr_b16 v[54:55], v5 offset:6976
    ds_read_b128 v[204:207], v1 offset:0
    v_mfma_f32_32x32x16_bf16 v[80:95], v[116:119], v[184:187], v[80:95]
    ds_read_b64_tr_b16 v[56:57], v5 offset:9216
    ds_read_b64_tr_b16 v[58:59], v5 offset:9984
    ds_read_b64_tr_b16 v[60:61], v5 offset:9280
    ds_read_b64_tr_b16 v[62:63], v5 offset:10048
    v_mfma_f32_32x32x16_bf16 v[64:79], v[120:123], v[188:191], v[64:79]
    v_mfma_f32_32x32x16_bf16 v[80:95], v[124:127], v[188:191], v[80:95]
    s_set_gpr_idx_on s68, gpr_idx(SRC0)
    v_dot2c_f32_bf16 v16, v96, v27
    v_dot2c_f32_bf16 v18, v100, v27
    v_dot2c_f32_bf16 v17, v104, v27
    v_dot2c_f32_bf16 v19, v108, v27
    v_dot2c_f32_bf16 v16, v112, v27
    v_dot2c_f32_bf16 v18, v116, v27
    v_dot2c_f32_bf16 v17, v120, v27
    v_dot2c_f32_bf16 v19, v124, v27
    s_set_gpr_idx_off
    s_add_u32 m0, s73, 0xc000
    s_add_u32 s78, s20, 7
    s_and_b32 s78, s78, 7
    s_lshl_b32 s78, s78, 7
    s_add_u32 s78, s78, s72
    buffer_load_dwordx4 v2, s[24:27], s78 offen lds
    s_add_u32 m0, s73, 0xc400
    s_nop 0
    buffer_load_dwordx4 v3, s[24:27], s78 offen lds
    s_add_u32 m0, s73, 0xc800
    s_add_u32 s78, s78, 0x4000
    buffer_load_dwordx4 v2, s[24:27], s78 offen lds
    s_add_u32 m0, s73, 0xcc00
    s_nop 0
    buffer_load_dwordx4 v3, s[24:27], s78 offen lds
    s_waitcnt vmcnt(8)
    s_waitcnt lgkmcnt(0)
    s_barrier
    v_mfma_f32_32x32x16_bf16 v[64:79], v[32:35], v[192:195], v[64:79]
    ds_read_b128 v[208:211], v13 offset:16384
    ds_read_b64_tr_b16 v[96:97], v5 offset:12288
    ds_read_b64_tr_b16 v[98:99], v5 offset:13056
    v_mfma_f32_32x32x16_bf16 v[80:95], v[36:39], v[192:195], v[80:95]
    ds_read_b64_tr_b16 v[100:101], v5 offset:12352
    ds_read_b64_tr_b16 v[102:103], v5 offset:13120
    ds_read_b128 v[212:215], v14 offset:16384
    v_mfma_f32_32x32x16_bf16 v[64:79], v[40:43], v[196:199], v[64:79]
    ds_read_b64_tr_b16 v[104:105], v5 offset:15360
    ds_read_b64_tr_b16 v[106:107], v5 offset:16128
    ds_read_b64_tr_b16 v[108:109], v5 offset:15424
    ds_read_b64_tr_b16 v[110:111], v5 offset:16192
    v_mfma_f32_32x32x16_bf16 v[80:95], v[44:47], v[196:199], v[80:95]
    ds_read_b128 v[216:219], v15 offset:16384
    ds_read_b64_tr_b16 v[112:113], v5 offset:18432
    ds_read_b64_tr_b16 v[114:115], v5 offset:19200
    v_mfma_f32_32x32x16_bf16 v[64:79], v[48:51], v[200:203], v[64:79]
    ds_read_b64_tr_b16 v[116:117], v5 offset:18496
    ds_read_b64_tr_b16 v[118:119], v5 offset:19264
    ds_read_b128 v[220:223], v1 offset:16384
    v_mfma_f32_32x32x16_bf16 v[80:95], v[52:55], v[200:203], v[80:95]
    ds_read_b64_tr_b16 v[120:121], v5 offset:21504
    ds_read_b64_tr_b16 v[122:123], v5 offset:22272
    ds_read_b64_tr_b16 v[124:125], v5 offset:21568
    ds_read_b64_tr_b16 v[126:127], v5 offset:22336
    v_mfma_f32_32x32x16_bf16 v[64:79], v[56:59], v[204:207], v[64:79]
    v_mfma_f32_32x32x16_bf16 v[80:95], v[60:63], v[204:207], v[80:95]
    s_set_gpr_idx_on s68, gpr_idx(SRC0)
    v_dot2c_f32_bf16 v16, v32, v27
    v_dot2c_f32_bf16 v18, v36, v27
    v_dot2c_f32_bf16 v17, v40, v27
    v_dot2c_f32_bf16 v19, v44, v27
    v_dot2c_f32_bf16 v16, v48, v27
    v_dot2c_f32_bf16 v18, v52, v27
    v_dot2c_f32_bf16 v17, v56, v27
    v_dot2c_f32_bf16 v19, v60, v27
    s_set_gpr_idx_off
    v_mov_b32 v23, 0
    buffer_load_dword v23, v23, s[52:55], 0 offen offset:0 sc1
    s_cmp_ge_u32 s11, 14
    s_cbranch_scc1 L_idle_7
    s_add_u32 m0, s75, 0x10000
    s_add_u32 s64, s74, 0
    s_and_b32 s64, s64, 31
    s_mul_i32 s64, s64, 0xe000
    buffer_load_dwordx4 v12, s[84:87], s64 offen lds
    s_add_u32 m0, s75, 0x12000
    s_add_u32 s64, s74, 1
    s_and_b32 s64, s64, 31
    s_mul_i32 s64, s64, 0xe000
    buffer_load_dwordx4 v12, s[84:87], s64 offen lds
    s_add_u32 m0, s75, 0x14000
    s_add_u32 s64, s74, 2
    s_and_b32 s64, s64, 31
    s_mul_i32 s64, s64, 0xe000
    buffer_load_dwordx4 v12, s[84:87], s64 offen lds
    s_add_u32 m0, s75, 0
    s_add_u32 s64, s74, 3
    s_and_b32 s64, s64, 31
    s_mul_i32 s64, s64, 0xe000
    buffer_load_dwordx4 v12, s[84:87], s64 offen lds
    s_add_u32 m0, s75, 0x2000
    s_add_u32 s64, s74, 4
    s_and_b32 s64, s64, 31
    s_mul_i32 s64, s64, 0xe000
    buffer_load_dwordx4 v12, s[84:87], s64 offen lds
    s_branch L_done_8
L_idle_7:
    s_mov_b32 s64, 0
    buffer_load_dwordx4 v[128:131], v12, s[84:87], s64 offen
    s_mov_b32 s64, 0x7000
    buffer_load_dwordx4 v[132:135], v12, s[84:87], s64 offen
    s_mov_b32 s64, 0xe000
    buffer_load_dwordx4 v[136:139], v12, s[84:87], s64 offen
    s_mov_b32 s64, 0x15000
    buffer_load_dwordx4 v[140:143], v12, s[84:87], s64 offen
L_done_8:
    s_waitcnt vmcnt(9)
    s_waitcnt lgkmcnt(0)
    s_barrier
    v_mfma_f32_32x32x16_bf16 v[64:79], v[96:99], v[208:211], v[64:79]
    ds_read_b128 v[224:227], v13 offset:32768
    ds_read_b64_tr_b16 v[32:33], v5 offset:24576
    ds_read_b64_tr_b16 v[34:35], v5 offset:25344
    v_mfma_f32_32x32x16_bf16 v[80:95], v[100:103], v[208:211], v[80:95]
    ds_read_b64_tr_b16 v[36:37], v5 offset:24640
    ds_read_b64_tr_b16 v[38:39], v5 offset:25408
    ds_read_b128 v[228:231], v14 offset:32768
    v_mfma_f32_32x32x16_bf16 v[64:79], v[104:107], v[212:215], v[64:79]
    ds_read_b64_tr_b16 v[40:41], v5 offset:27648
    ds_read_b64_tr_b16 v[42:43], v5 offset:28416
    ds_read_b64_tr_b16 v[44:45], v5 offset:27712
    ds_read_b64_tr_b16 v[46:47], v5 offset:28480
    v_mfma_f32_32x32x16_bf16 v[80:95], v[108:111], v[212:215], v[80:95]
    ds_read_b128 v[232:235], v15 offset:32768
    ds_read_b64_tr_b16 v[48:49], v5 offset:30720
    ds_read_b64_tr_b16 v[50:51], v5 offset:31488
    v_mfma_f32_32x32x16_bf16 v[64:79], v[112:115], v[216:219], v[64:79]
    ds_read_b64_tr_b16 v[52:53], v5 offset:30784
    ds_read_b64_tr_b16 v[54:55], v5 offset:31552
    ds_read_b128 v[236:239], v1 offset:32768
    v_mfma_f32_32x32x16_bf16 v[80:95], v[116:119], v[216:219], v[80:95]
    ds_read_b64_tr_b16 v[56:57], v5 offset:33792
    ds_read_b64_tr_b16 v[58:59], v5 offset:34560
    ds_read_b64_tr_b16 v[60:61], v5 offset:33856
    ds_read_b64_tr_b16 v[62:63], v5 offset:34624
    v_mfma_f32_32x32x16_bf16 v[64:79], v[120:123], v[220:223], v[64:79]
    v_mfma_f32_32x32x16_bf16 v[80:95], v[124:127], v[220:223], v[80:95]
    s_set_gpr_idx_on s68, gpr_idx(SRC0)
    v_dot2c_f32_bf16 v16, v96, v27
    v_dot2c_f32_bf16 v18, v100, v27
    v_dot2c_f32_bf16 v17, v104, v27
    v_dot2c_f32_bf16 v19, v108, v27
    v_dot2c_f32_bf16 v16, v112, v27
    v_dot2c_f32_bf16 v18, v116, v27
    v_dot2c_f32_bf16 v17, v120, v27
    v_dot2c_f32_bf16 v19, v124, v27
    s_set_gpr_idx_off
    s_cmp_ge_u32 s11, 14
    s_cbranch_scc1 L_idle_9
    s_add_u32 m0, s75, 0x4000
    s_add_u32 s64, s74, 5
    s_and_b32 s64, s64, 31
    s_mul_i32 s64, s64, 0xe000
    buffer_load_dwordx4 v12, s[84:87], s64 offen lds
    s_add_u32 m0, s75, 0x6000
    s_add_u32 s64, s74, 6
    s_and_b32 s64, s64, 31
    s_mul_i32 s64, s64, 0xe000
    buffer_load_dwordx4 v12, s[84:87], s64 offen lds
    s_branch L_done_10
L_idle_9:
    s_mov_b32 s64, 0x1c000
    buffer_load_dwordx4 v[144:147], v12, s[84:87], s64 offen
    s_mov_b32 s64, 0x23000
    buffer_load_dwordx4 v[148:151], v12, s[84:87], s64 offen
    s_mov_b32 s64, 0x2a000
    buffer_load_dwordx4 v[152:155], v12, s[84:87], s64 offen
    s_mov_b32 s64, 0x31000
    buffer_load_dwordx4 v[156:159], v12, s[84:87], s64 offen
L_done_10:
    s_waitcnt vmcnt(8)
    s_waitcnt lgkmcnt(0)
    s_barrier
    v_mfma_f32_32x32x16_bf16 v[64:79], v[32:35], v[224:227], v[64:79]
    ds_read_b128 v[240:243], v13 offset:49152
    ds_read_b64_tr_b16 v[96:97], v5 offset:36864
    ds_read_b64_tr_b16 v[98:99], v5 offset:37632
    v_mfma_f32_32x32x16_bf16 v[80:95], v[36:39], v[224:227], v[80:95]
    ds_read_b64_tr_b16 v[100:101], v5 offset:36928
    ds_read_b64_tr_b16 v[102:103], v5 offset:37696
    ds_read_b128 v[244:247], v14 offset:49152
    v_mfma_f32_32x32x16_bf16 v[64:79], v[40:43], v[228:231], v[64:79]
    ds_read_b64_tr_b16 v[104:105], v5 offset:39936
    ds_read_b64_tr_b16 v[106:107], v5 offset:40704
    ds_read_b64_tr_b16 v[108:109], v5 offset:40000
    ds_read_b64_tr_b16 v[110:111], v5 offset:40768
    v_mfma_f32_32x32x16_bf16 v[80:95], v[44:47], v[228:231], v[80:95]
    ds_read_b128 v[248:251], v15 offset:49152
    ds_read_b64_tr_b16 v[112:113], v5 offset:43008
    ds_read_b64_tr_b16 v[114:115], v5 offset:43776
    v_mfma_f32_32x32x16_bf16 v[64:79], v[48:51], v[232:235], v[64:79]
    ds_read_b64_tr_b16 v[116:117], v5 offset:43072
    ds_read_b64_tr_b16 v[118:119], v5 offset:43840
    ds_read_b128 v[252:255], v1 offset:49152
    v_mfma_f32_32x32x16_bf16 v[80:95], v[52:55], v[232:235], v[80:95]
    ds_read_b64_tr_b16 v[120:121], v5 offset:46080
    ds_read_b64_tr_b16 v[122:123], v5 offset:46848
    ds_read_b64_tr_b16 v[124:125], v5 offset:46144
    ds_read_b64_tr_b16 v[126:127], v5 offset:46912
    v_mfma_f32_32x32x16_bf16 v[64:79], v[56:59], v[236:239], v[64:79]
    v_mfma_f32_32x32x16_bf16 v[80:95], v[60:63], v[236:239], v[80:95]
    s_set_gpr_idx_on s68, gpr_idx(SRC0)
    v_dot2c_f32_bf16 v16, v32, v27
    v_dot2c_f32_bf16 v18, v36, v27
    v_dot2c_f32_bf16 v17, v40, v27
    v_dot2c_f32_bf16 v19, v44, v27
    v_dot2c_f32_bf16 v16, v48, v27
    v_dot2c_f32_bf16 v18, v52, v27
    v_dot2c_f32_bf16 v17, v56, v27
    v_dot2c_f32_bf16 v19, v60, v27
    s_set_gpr_idx_off
    s_cmp_ge_u32 s11, 14
    s_cbranch_scc1 L_idle_11
    s_add_u32 m0, s75, 0x8000
    s_add_u32 s64, s74, 7
    s_and_b32 s64, s64, 31
    s_mul_i32 s64, s64, 0xe000
    buffer_load_dwordx4 v12, s[84:87], s64 offen lds
    s_add_u32 m0, s75, 0xa000
    s_add_u32 s64, s74, 8
    s_and_b32 s64, s64, 31
    s_mul_i32 s64, s64, 0xe000
    buffer_load_dwordx4 v12, s[84:87], s64 offen lds
    s_add_u32 m0, s75, 0x18000
    s_add_u32 s64, s74, 11
    s_and_b32 s64, s64, 31
    s_mul_i32 s64, s64, 0xe000
    buffer_load_dwordx4 v12, s[84:87], s64 offen lds
    s_add_u32 m0, s75, 0x1a000
    s_add_u32 s64, s74, 12
    s_and_b32 s64, s64, 31
    s_mul_i32 s64, s64, 0xe000
    buffer_load_dwordx4 v12, s[84:87], s64 offen lds
    s_branch L_done_12
L_idle_11:
    s_mov_b32 s64, 0x38000
    buffer_load_dwordx4 v[160:163], v12, s[84:87], s64 offen
    s_mov_b32 s64, 0x3f000
    buffer_load_dwordx4 v[164:167], v12, s[84:87], s64 offen
    s_mov_b32 s64, 0x46000
    buffer_load_dwordx4 v[168:171], v12, s[84:87], s64 offen
    s_mov_b32 s64, 0x4d000
    buffer_load_dwordx4 v[172:175], v12, s[84:87], s64 offen
L_done_12:
    s_set_gpr_idx_on s68, gpr_idx(SRC0)
    s_waitcnt lgkmcnt(15)
    v_dot2c_f32_bf16 v16, v96, v27
    v_dot2c_f32_bf16 v18, v100, v27
    s_waitcnt lgkmcnt(12)
    v_dot2c_f32_bf16 v17, v104, v27
    s_waitcnt lgkmcnt(10)
    v_dot2c_f32_bf16 v19, v108, v27
    s_waitcnt lgkmcnt(7)
    v_dot2c_f32_bf16 v16, v112, v27
    s_waitcnt lgkmcnt(5)
    v_dot2c_f32_bf16 v18, v116, v27
    s_waitcnt lgkmcnt(2)
    v_dot2c_f32_bf16 v17, v120, v27
    s_waitcnt lgkmcnt(0)
    v_dot2c_f32_bf16 v19, v124, v27
    s_set_gpr_idx_off
    v_and_b32 v21, 31, v0
    s_lshl_b32 s64, s68, 7
    s_add_u32 s66, s64, 0x16000
    v_lshl_add_u32 v20, v21, 2, s66
    v_lshlrev_b32 v21, 2, v21
    v_add_u32 v21, 0x16600, v21
    v_add_f32 v16, v16, v17
    v_mov_b32 v17, v16
    s_nop 1
    v_permlane32_swap_b32 v16, v17
    v_add_f32 v16, v16, v17
    ds_write_b32 v20, v16 offset:1536
    v_add_f32 v18, v18, v19
    v_mov_b32 v19, v18
    s_nop 1
    v_permlane32_swap_b32 v18, v19
    v_add_f32 v18, v18, v19
    ds_write_b32 v20, v18 offset:2048
    v_mfma_f32_32x32x16_bf16 v[64:79], v[96:99], v[240:243], v[64:79]
    v_mfma_f32_32x32x16_bf16 v[80:95], v[100:103], v[240:243], v[80:95]
    v_mfma_f32_32x32x16_bf16 v[64:79], v[104:107], v[244:247], v[64:79]
    v_mfma_f32_32x32x16_bf16 v[80:95], v[108:111], v[244:247], v[80:95]
    v_mfma_f32_32x32x16_bf16 v[64:79], v[112:115], v[248:251], v[64:79]
    v_mfma_f32_32x32x16_bf16 v[80:95], v[116:119], v[248:251], v[80:95]
    v_mfma_f32_32x32x16_bf16 v[64:79], v[120:123], v[252:255], v[64:79]
    v_mfma_f32_32x32x16_bf16 v[80:95], v[124:127], v[252:255], v[80:95]
    s_cmp_ge_u32 s11, 14
    s_cbranch_scc1 L_idle_13
    s_add_u32 m0, s75, 0x1c000
    s_add_u32 s64, s74, 13
    s_and_b32 s64, s64, 31
    s_mul_i32 s64, s64, 0xe000
    buffer_load_dwordx4 v12, s[84:87], s64 offen lds
    s_add_u32 m0, s75, 0x1e000
    s_add_u32 s64, s74, 14
    s_and_b32 s64, s64, 31
    s_mul_i32 s64, s64, 0xe000
    buffer_load_dwordx4 v12, s[84:87], s64 offen lds
    s_branch L_done_14
L_idle_13:
    s_mov_b32 s64, 0x54000
    buffer_load_dwordx4 v[176:179], v12, s[84:87], s64 offen
    s_mov_b32 s64, 0x5b000
    buffer_load_dwordx4 v[180:183], v12, s[84:87], s64 offen
    s_mov_b32 s64, 0x62000
    buffer_load_dwordx4 v[184:187], v12, s[84:87], s64 offen
    s_mov_b32 s64, 0x69000
    buffer_load_dwordx4 v[188:191], v12, s[84:87], s64 offen
L_done_14:
    s_waitcnt vmcnt(13)
    v_readfirstlane_b32 s63, v23
    s_waitcnt vmcnt(9)
    s_waitcnt lgkmcnt(0)
    s_barrier
    s_mul_i32 s63, s63, 0x9e3779b1
    s_add_u32 s63, s63, 0x7f4a7c15
    v_mov_b32 v1, v12
    v_mov_b32 v5, v22
    ds_read_b32 v24, v21 offset:0
    ds_read_b32 v25, v21 offset:128
    ds_read_b32 v26, v21 offset:256
    ds_read_b32 v27, v21 offset:384
    ds_read_b32 v12, v21 offset:512
    ds_read_b32 v13, v21 offset:640
    ds_read_b32 v14, v21 offset:768
    ds_read_b32 v15, v21 offset:896
    ds_read_b32 v28, v20 offset:1024
    ds_read_b32 v3, v20
    ds_read_b32 v2, v20 offset:512
    v_add_u32 v8, 0x10000, v8
    ds_read_b64_tr_b16 v[32:33], v8 offset:0
    ds_read_b64_tr_b16 v[34:35], v8 offset:1024
    v_add_u32 v9, 0x10000, v9
    ds_read_b64_tr_b16 v[36:37], v9 offset:0
    ds_read_b64_tr_b16 v[38:39], v9 offset:1024
    ds_read_b64_tr_b16 v[40:41], v8 offset:8192
    ds_read_b64_tr_b16 v[42:43], v8 offset:9216
    ds_read_b64_tr_b16 v[44:45], v9 offset:8192
    ds_read_b64_tr_b16 v[46:47], v9 offset:9216
    ds_read_b64_tr_b16 v[48:49], v8 offset:16384
    ds_read_b64_tr_b16 v[50:51], v8 offset:17408
    ds_read_b64_tr_b16 v[52:53], v9 offset:16384
    ds_read_b64_tr_b16 v[54:55], v9 offset:17408
    s_cmp_ge_u32 s11, 14
    s_cbranch_scc1 L_idle_15
    s_add_u32 m0, s75, 0xc000
    s_add_u32 s64, s74, 9
    s_and_b32 s64, s64, 31
    s_mul_i32 s64, s64, 0xe000
    buffer_load_dwordx4 v1, s[84:87], s64 offen lds
    s_add_u32 m0, s75, 0xe000
    s_add_u32 s64, s74, 10
    s_and_b32 s64, s64, 31
    s_mul_i32 s64, s64, 0xe000
    buffer_load_dwordx4 v1, s[84:87], s64 offen lds
    s_branch L_done_16
L_idle_15:
L_done_16:
    s_lshl_b32 s64, s57, 2
    s_add_u32 s67, s64, s68
    s_lshl_b32 s64, s67, 10
    s_lshr_b32 s65, s58, 1
    s_lshl_b32 s65, s65, 18
    s_add_u32 s66, s64, s65
    s_waitcnt lgkmcnt(15)
    v_add_f32 v24, v24, v25
    v_add_f32 v26, v26, v27
    v_add_f32 v24, v24, v26
    v_and_b32 v29, s61, v24
    v_sub_f32 v30, v24, v29
    s_waitcnt lgkmcnt(10)
    v_mfma_f32_32x32x16_bf16 v[96:111], v[32:35], v[128:131], 0
    v_add_u32 v8, 0xffff0000, v8
    ds_read_b64_tr_b16 v[56:57], v8 offset:0
    ds_read_b64_tr_b16 v[58:59], v8 offset:1024
    v_cvt_pk_bf16_f32 v24, v29, v29
    v_cvt_pk_bf16_f32 v25, v30, 0
    v_and_b32 v24, v5, v24
    v_and_b32 v25, v5, v25
    v_mov_b32 v26, 0
    v_mov_b32 v27, 0
    v_add_f32 v12, v12, v13
    v_add_f32 v14, v14, v15
    v_add_f32 v12, v12, v14
    v_and_b32 v29, s61, v12
    v_sub_f32 v30, v12, v29
    s_waitcnt lgkmcnt(10)
    v_mfma_f32_32x32x16_bf16 v[112:127], v[36:39], v[128:131], 0
    v_add_u32 v9, 0xffff0000, v9
    ds_read_b64_tr_b16 v[60:61], v9 offset:0
    ds_read_b64_tr_b16 v[62:63], v9 offset:1024
    v_cvt_pk_bf16_f32 v12, v29, v29
    v_cvt_pk_bf16_f32 v13, v30, 0
    v_and_b32 v12, v5, v12
    v_and_b32 v13, v5, v13
    v_mov_b32 v14, 0
    v_mov_b32 v15, 0
    v_and_b32 v29, s61, v28
    v_sub_f32 v30, v28, v29
    v_cvt_pk_bf16_f32 v16, v29, v30
    v_cvt_pk_bf16_f32 v17, v29, 0
    v_and_b32 v16, v5, v16
    s_waitcnt lgkmcnt(10)
    v_mfma_f32_32x32x16_bf16 v[96:111], v[40:43], v[132:135], v[96:111]
    v_add_u32 v6, 0x10000, v6
    ds_read_b64_tr_b16 v[32:33], v6 offset:0
    ds_read_b64_tr_b16 v[34:35], v6 offset:1024
    v_and_b32 v17, v5, v17
    v_mov_b32 v18, 0
    v_mov_b32 v19, 0
    s_nop 1
    v_mfma_f32_32x32x16_bf16 v[64:79], v[24:27], v[16:19], v[64:79]
    v_mfma_f32_32x32x16_bf16 v[80:95], v[12:15], v[16:19], v[80:95]
    s_cmp_eq_u32 s82, 0
    s_cselect_b32 s65, 0x3eb8aa3b, 1.0
    s_cselect_b32 s64, 0, 0x200000
    s_add_u32 s66, s66, s64
    s_add_u32 s66, s66, 0x60000
    v_mul_f32 v4, s65, v3
    s_waitcnt lgkmcnt(10)
    v_mfma_f32_32x32x16_bf16 v[112:127], v[44:47], v[132:135], v[112:127]
    v_add_u32 v7, 0x10000, v7
    ds_read_b64_tr_b16 v[36:37], v7 offset:0
    ds_read_b64_tr_b16 v[38:39], v7 offset:1024
    v_mul_f32 v64, v4, v64
    v_mul_f32 v65, v4, v65
    v_mul_f32 v66, v4, v66
    v_mul_f32 v67, v4, v67
    v_mul_f32 v68, v4, v68
    v_mul_f32 v69, v4, v69
    v_mul_f32 v70, v4, v70
    v_mul_f32 v71, v4, v71
    v_mul_f32 v72, v4, v72
    v_mul_f32 v73, v4, v73
    v_mul_f32 v74, v4, v74
    s_waitcnt lgkmcnt(10)
    v_mfma_f32_32x32x16_bf16 v[96:111], v[48:51], v[136:139], v[96:111]
    ds_read_b64_tr_b16 v[40:41], v6 offset:8192
    ds_read_b64_tr_b16 v[42:43], v6 offset:9216
    v_mul_f32 v75, v4, v75
    v_mul_f32 v76, v4, v76
    v_mul_f32 v77, v4, v77
    v_mul_f32 v78, v4, v78
    v_mul_f32 v79, v4, v79
    v_cvt_pk_bf16_f32 v12, v64, v65
    v_cvt_pk_bf16_f32 v13, v66, v67
    v_cvt_pk_bf16_f32 v14, v68, v69
    v_cvt_pk_bf16_f32 v15, v70, v71
    v_cvt_pk_bf16_f32 v20, v72, v73
    v_cvt_pk_bf16_f32 v21, v74, v75
    s_waitcnt lgkmcnt(10)
    v_mfma_f32_32x32x16_bf16 v[112:127], v[52:55], v[136:139], v[112:127]
    ds_read_b64_tr_b16 v[44:45], v7 offset:8192
    ds_read_b64_tr_b16 v[46:47], v7 offset:9216
    v_cvt_pk_bf16_f32 v22, v76, v77
    v_cvt_pk_bf16_f32 v23, v78, v79
    s_add_u32 s64, s66, 0
    buffer_store_dwordx4 v[12:15], v11, s[52:55], s64 offen sc1
    v_mul_f32 v80, v4, v80
    v_mul_f32 v81, v4, v81
    v_mul_f32 v82, v4, v82
    v_mul_f32 v83, v4, v83
    v_mul_f32 v84, v4, v84
    v_mul_f32 v85, v4, v85
    v_mul_f32 v86, v4, v86
    s_waitcnt lgkmcnt(10)
    v_mfma_f32_32x32x16_bf16 v[96:111], v[56:59], v[140:143], v[96:111]
    ds_read_b64_tr_b16 v[48:49], v6 offset:16384
    ds_read_b64_tr_b16 v[50:51], v6 offset:17408
    v_mul_f32 v87, v4, v87
    v_mul_f32 v88, v4, v88
    v_mul_f32 v89, v4, v89
    v_mul_f32 v90, v4, v90
    v_mul_f32 v91, v4, v91
    v_mul_f32 v92, v4, v92
    v_mul_f32 v93, v4, v93
    v_mul_f32 v94, v4, v94
    v_mul_f32 v95, v4, v95
    v_cvt_pk_bf16_f32 v24, v80, v81
    v_cvt_pk_bf16_f32 v25, v82, v83
    s_waitcnt lgkmcnt(10)
    v_mfma_f32_32x32x16_bf16 v[112:127], v[60:63], v[140:143], v[112:127]
    ds_read_b64_tr_b16 v[52:53], v7 offset:16384
    ds_read_b64_tr_b16 v[54:55], v7 offset:17408
    v_cvt_pk_bf16_f32 v26, v84, v85
    v_cvt_pk_bf16_f32 v27, v86, v87
    v_cvt_pk_bf16_f32 v28, v88, v89
    v_cvt_pk_bf16_f32 v29, v90, v91
    v_cvt_pk_bf16_f32 v30, v92, v93
    v_cvt_pk_bf16_f32 v31, v94, v95
    v_mul_f32 v3, 0xbfb8aa3b, v3
    s_branch L_up
L_hf1:
    s_setprio 0
    v_bfe_u32 v60, v0, 4, 1
    v_lshrrev_b32 v61, 5, v0
    v_bfe_u32 v62, v0, 2, 2
    v_and_b32 v63, 3, v0
    v_and_b32 v28, 31, v0
    v_bfe_u32 v29, v0, 1, 3
    v_xor_b32 v29, v29, v61
    v_lshlrev_b32 v29, 4, v29
    v_lshl_add_u32 v28, v28, 7, v29
    s_and_b32 s64, s56, 3
    s_lshl_b32 s64, s64, 12
    v_add_u32 v13, s64, v28
    v_xor_b32 v14, 32, v13
    v_xor_b32 v15, 64, v13
    v_xor_b32 v1, 0x60, v13
    v_lshl_add_u32 v28, v61, 3, v62
    v_mul_u32_u24 v29, 0xc0, v28
    v_lshl_add_u32 v29, v60, 5, v29
    v_lshl_add_u32 v29, v63, 3, v29
    v_add_u32 v4, 0x10000, v29
    v_add_u32 v5, 0x1c000, v29
    v_lshlrev_b32 v28, 8, v28
    v_lshl_add_u32 v28, v60, 12, v28
    v_lshl_add_u32 v28, v63, 3, v28
    v_lshl_add_u32 v29, v60, 2, v62
    v_lshl_add_u32 v6, v29, 5, v28
    s_mov_b32 s62, 0x3f803f80
    s_add_u32 m0, s71, 0x13000
    s_add_u32 s78, s20, 1
    s_and_b32 s78, s78, 7
    s_mul_i32 s78, s78, 0x30000
    buffer_load_dwordx4 v24, s[28:31], s78 offen lds
    s_add_u32 m0, s71, 0x13400
    s_nop 0
    buffer_load_dwordx4 v25, s[28:31], s78 offen lds
    s_add_u32 m0, s71, 0x13800
    s_nop 0
    buffer_load_dwordx4 v26, s[28:31], s78 offen lds
    s_add_u32 m0, s71, 0x16000
    s_add_u32 s78, s20, 2
    s_and_b32 s78, s78, 7
    s_mul_i32 s78, s78, 0x30000
    buffer_load_dwordx4 v24, s[28:31], s78 offen lds
    s_add_u32 m0, s71, 0x16400
    s_nop 0
    buffer_load_dwordx4 v25, s[28:31], s78 offen lds
    s_add_u32 m0, s71, 0x16800
    s_nop 0
    buffer_load_dwordx4 v26, s[28:31], s78 offen lds
    v_mov_b32 v27, s62
    v_mov_b32 v16, 0
    v_mov_b32 v17, 0
    s_and_b32 s68, s56, 3
    s_mov_b32 s36, s12
    s_mov_b32 s37, s13
    s_mov_b32 s38, 0x1c0000
    s_mov_b32 s39, 0x20000
    s_mov_b32 s40, s14
    s_mov_b32 s41, s15
    s_mov_b32 s42, 0x1c0000
    s_mov_b32 s43, 0x20000
    s_mov_b32 s84, s14
    s_mov_b32 s85, s15
    s_mov_b32 s86, 0x1c0000
    s_mov_b32 s87, 0x20000
    s_mov_b32 s52, s22
    s_mov_b32 s53, s23
    s_mov_b32 s54, 0xfa0000
    s_mov_b32 s55, 0x20000
    s_lshl_b32 s75, s56, 10
    s_lshl_b32 s74, s20, 2
    s_waitcnt lgkmcnt(0)
    s_waitcnt vmcnt(6)
    s_barrier
    ds_read_b128 v[128:131], v13 offset:0
    ds_read_b64_tr_b16 v[32:33], v4 offset:128
    ds_read_b64_tr_b16 v[34:35], v4 offset:896
    ds_read_b128 v[132:135], v14 offset:0
    ds_read_b64_tr_b16 v[36:37], v4 offset:3200
    ds_read_b64_tr_b16 v[38:39], v4 offset:3968
    ds_read_b128 v[136:139], v15 offset:0
    ds_read_b64_tr_b16 v[40:41], v4 offset:6272
    ds_read_b64_tr_b16 v[42:43], v4 offset:7040
    ds_read_b128 v[140:143], v1 offset:0
    ds_read_b64_tr_b16 v[44:45], v4 offset:9344
    ds_read_b64_tr_b16 v[46:47], v4 offset:10112
    s_add_u32 m0, s71, 0x19000
    s_add_u32 s78, s20, 3
    s_and_b32 s78, s78, 7
    s_mul_i32 s78, s78, 0x30000
    buffer_load_dwordx4 v24, s[28:31], s78 offen lds
    s_add_u32 m0, s71, 0x19400
    s_nop 0
    buffer_load_dwordx4 v25, s[28:31], s78 offen lds
    s_add_u32 m0, s71, 0x19800
    s_nop 0
    buffer_load_dwordx4 v26, s[28:31], s78 offen lds
    s_waitcnt lgkmcnt(9)
    v_mfma_f32_32x32x16_bf16 v[64:79], v[128:131], v[32:35], 0
    s_waitcnt lgkmcnt(6)
    v_mfma_f32_32x32x16_bf16 v[64:79], v[132:135], v[36:39], v[64:79]
    s_waitcnt lgkmcnt(3)
    v_mfma_f32_32x32x16_bf16 v[64:79], v[136:139], v[40:43], v[64:79]
    s_waitcnt lgkmcnt(0)
    v_mfma_f32_32x32x16_bf16 v[64:79], v[140:143], v[44:47], v[64:79]
    v_lshrrev_b32 v28, 4, v0
    v_lshlrev_b32 v29, 1, v28
    v_xor_b32 v29, 8, v29
    v_and_b32 v21, 15, v0
    v_xor_b32 v29, v29, v21
    v_mul_u32_u24 v28, 0xe00, v28
    v_lshl_add_u32 v28, v29, 4, v28
    s_and_b32 s64, s56, 3
    s_mul_i32 s64, s64, 0x3800
    s_lshr_b32 s65, s58, 3
    s_sub_u32 s11, s58, s65
    s_and_b32 s65, s58, 7
    s_cmp_eq_u32 s65, 7
    s_cselect_b32 s11, 14, s11
    s_lshl_b32 s65, s11, 8
    s_add_u32 s64, s64, s65
    v_add_u32 v12, s64, v28
    s_cmp_ge_u32 s11, 14
    s_cbranch_scc1 L_idle_17
    s_branch L_done_18
L_idle_17:
    s_lshl_b32 s64, s57, 1
    s_lshr_b32 s65, s58, 3
    s_add_u32 s21, s64, s65
    v_lshrrev_b32 v28, 3, v0
    v_mul_u32_u24 v28, 0xe00, v28
    v_and_b32 v29, 7, v0
    v_lshl_add_u32 v28, v29, 4, v28
    s_and_b32 s64, s56, 3
    s_mul_i32 s64, s64, 0x70000
    s_lshl_b32 s65, s21, 7
    s_add_u32 s64, s64, s65
    s_cmp_ge_u32 s21, 28
    s_cselect_b32 s65, 0x40000000, 0
    s_add_u32 s64, s64, s65
    v_add_u32 v12, s64, v28
L_done_18:
    s_set_gpr_idx_on s68, gpr_idx(SRC0)
    v_dot2c_f32_bf16 v16, v32, v27
    v_dot2c_f32_bf16 v17, v36, v27
    v_dot2c_f32_bf16 v16, v40, v27
    v_dot2c_f32_bf16 v17, v44, v27
    s_set_gpr_idx_off
    v_dot2_f32_bf16 v100, v128, v27, 0
    v_dot2_f32_bf16 v102, v128, v128, 0
    v_dot2_f32_bf16 v101, v129, v27, 0
    v_dot2_f32_bf16 v103, v129, v129, 0
    v_dot2_f32_bf16 v100, v130, v27, v100
    v_dot2_f32_bf16 v102, v130, v130, v102
    v_dot2_f32_bf16 v101, v131, v27, v101
    v_dot2_f32_bf16 v103, v131, v131, v103
    v_dot2_f32_bf16 v100, v132, v27, v100
    v_dot2_f32_bf16 v102, v132, v132, v102
    v_dot2_f32_bf16 v101, v133, v27, v101
    v_dot2_f32_bf16 v103, v133, v133, v103
    v_dot2_f32_bf16 v100, v134, v27, v100
    v_dot2_f32_bf16 v102, v134, v134, v102
    v_dot2_f32_bf16 v101, v135, v27, v101
    v_dot2_f32_bf16 v103, v135, v135, v103
    v_dot2_f32_bf16 v100, v136, v27, v100
    v_dot2_f32_bf16 v102, v136, v136, v102
    v_dot2_f32_bf16 v101, v137, v27, v101
    v_dot2_f32_bf16 v103, v137, v137, v103
    v_dot2_f32_bf16 v100, v138, v27, v100
    v_dot2_f32_bf16 v102, v138, v138, v102
    v_dot2_f32_bf16 v101, v139, v27, v101
    v_dot2_f32_bf16 v103, v139, v139, v103
    v_dot2_f32_bf16 v100, v140, v27, v100
    v_dot2_f32_bf16 v102, v140, v140, v102
    v_dot2_f32_bf16 v101, v141, v27, v101
    v_dot2_f32_bf16 v103, v141, v141, v103
    v_dot2_f32_bf16 v100, v142, v27, v100
    v_dot2_f32_bf16 v102, v142, v142, v102
    v_dot2_f32_bf16 v101, v143, v27, v101
    v_dot2_f32_bf16 v103, v143, v143, v103
    s_waitcnt vmcnt(6)
    s_barrier
    ds_read_b128 v[144:147], v13 offset:16384
    ds_read_b64_tr_b16 v[48:49], v4 offset:12416
    ds_read_b64_tr_b16 v[50:51], v4 offset:13184
    ds_read_b128 v[148:151], v14 offset:16384
    ds_read_b64_tr_b16 v[52:53], v4 offset:15488
    ds_read_b64_tr_b16 v[54:55], v4 offset:16256
    ds_read_b128 v[152:155], v15 offset:16384
    ds_read_b64_tr_b16 v[56:57], v4 offset:18560
    ds_read_b64_tr_b16 v[58:59], v4 offset:19328
    ds_read_b128 v[156:159], v1 offset:16384
    ds_read_b64_tr_b16 v[60:61], v4 offset:21632
    ds_read_b64_tr_b16 v[62:63], v4 offset:22400
    s_waitcnt vmcnt(3)
    s_waitcnt lgkmcnt(0)
    s_barrier
    s_add_u32 m0, s71, 0x1c000
    s_add_u32 s78, s20, 4
    s_and_b32 s78, s78, 7
    s_mul_i32 s78, s78, 0x30000
    buffer_load_dwordx4 v24, s[28:31], s78 offen lds
    s_add_u32 m0, s71, 0x1c400
    s_nop 0
    buffer_load_dwordx4 v25, s[28:31], s78 offen lds
    s_add_u32 m0, s71, 0x1c800
    s_nop 0
    buffer_load_dwordx4 v26, s[28:31], s78 offen lds
    s_add_u32 m0, s71, 0x1f000
    s_add_u32 s78, s20, 5
    s_and_b32 s78, s78, 7
    s_mul_i32 s78, s78, 0x30000
    buffer_load_dwordx4 v24, s[28:31], s78 offen lds
    s_add_u32 m0, s71, 0x1f400
    s_nop 0
    buffer_load_dwordx4 v25, s[28:31], s78 offen lds
    s_add_u32 m0, s71, 0x1f800
    s_nop 0
    buffer_load_dwordx4 v26, s[28:31], s78 offen lds
    v_mfma_f32_32x32x16_bf16 v[64:79], v[144:147], v[48:51], v[64:79]
    ds_read_b128 v[160:163], v13 offset:32768
    ds_read_b64_tr_b16 v[32:33], v4 offset:24704
    ds_read_b64_tr_b16 v[34:35], v4 offset:25472
    v_mfma_f32_32x32x16_bf16 v[64:79], v[148:151], v[52:55], v[64:79]
    ds_read_b128 v[164:167], v14 offset:32768
    ds_read_b64_tr_b16 v[36:37], v4 offset:27776
    ds_read_b64_tr_b16 v[38:39], v4 offset:28544
    v_mfma_f32_32x32x16_bf16 v[64:79], v[152:155], v[56:59], v[64:79]
    ds_read_b128 v[168:171], v15 offset:32768
    ds_read_b64_tr_b16 v[40:41], v4 offset:30848
    ds_read_b64_tr_b16 v[42:43], v4 offset:31616
    v_mfma_f32_32x32x16_bf16 v[64:79], v[156:159], v[60:63], v[64:79]
    ds_read_b128 v[172:175], v1 offset:32768
    ds_read_b64_tr_b16 v[44:45], v4 offset:33920
    ds_read_b64_tr_b16 v[46:47], v4 offset:34688
    v_xor_b32 v6, 0x80, v6
    v_xor_b32 v7, 32, v6
    v_xor_b32 v8, 64, v6
    v_xor_b32 v9, 0x60, v6
    s_mov_b32 s61, 0xffff0000
    s_mov_b32 s83, 0x3f80
    s_mov_b32 s3, 0x3f800000
    s_mul_i32 s76, s56, 0x420
    s_and_b32 s82, s58, 1
    v_cmp_gt_u32 vcc, 32, v0
    v_lshlrev_b32 v10, 4, v0
    s_nop 0
    v_cndmask_b32 v22, 0, -1, vcc
    s_set_gpr_idx_on s68, gpr_idx(SRC0)
    v_dot2c_f32_bf16 v16, v48, v27
    v_dot2c_f32_bf16 v17, v52, v27
    v_dot2c_f32_bf16 v16, v56, v27
    v_dot2c_f32_bf16 v17, v60, v27
    s_set_gpr_idx_off
    v_dot2_f32_bf16 v100, v144, v27, v100
    v_dot2_f32_bf16 v102, v144, v144, v102
    v_dot2_f32_bf16 v101, v145, v27, v101
    v_dot2_f32_bf16 v103, v145, v145, v103
    v_dot2_f32_bf16 v100, v146, v27, v100
    v_dot2_f32_bf16 v102, v146, v146, v102
    v_dot2_f32_bf16 v101, v147, v27, v101
    v_dot2_f32_bf16 v103, v147, v147, v103
    v_dot2_f32_bf16 v100, v148, v27, v100
    v_dot2_f32_bf16 v102, v148, v148, v102
    v_dot2_f32_bf16 v101, v149, v27, v101
    v_dot2_f32_bf16 v103, v149, v149, v103
    v_dot2_f32_bf16 v100, v150, v27, v100
    v_dot2_f32_bf16 v102, v150, v150, v102
    v_dot2_f32_bf16 v101, v151, v27, v101
    v_dot2_f32_bf16 v103, v151, v151, v103
    v_dot2_f32_bf16 v100, v152, v27, v100
    v_dot2_f32_bf16 v102, v152, v152, v102
    v_dot2_f32_bf16 v101, v153, v27, v101
    v_dot2_f32_bf16 v103, v153, v153, v103
    v_dot2_f32_bf16 v100, v154, v27, v100
    v_dot2_f32_bf16 v102, v154, v154, v102
    v_dot2_f32_bf16 v101, v155, v27, v101
    v_dot2_f32_bf16 v103, v155, v155, v103
    v_dot2_f32_bf16 v100, v156, v27, v100
    v_dot2_f32_bf16 v102, v156, v156, v102
    v_dot2_f32_bf16 v101, v157, v27, v101
    v_dot2_f32_bf16 v103, v157, v157, v103
    v_dot2_f32_bf16 v100, v158, v27, v100
    v_dot2_f32_bf16 v102, v158, v158, v102
    v_dot2_f32_bf16 v101, v159, v27, v101
    v_dot2_f32_bf16 v103, v159, v159, v103
    s_waitcnt vmcnt(6)
    s_waitcnt lgkmcnt(0)
    s_barrier
    s_add_u32 m0, s71, 0x22000
    s_add_u32 s78, s20, 6
    s_and_b32 s78, s78, 7
    s_mul_i32 s78, s78, 0x30000
    buffer_load_dwordx4 v24, s[28:31], s78 offen lds
    s_add_u32 m0, s71, 0x22400
    s_nop 0
    buffer_load_dwordx4 v25, s[28:31], s78 offen lds
    s_add_u32 m0, s71, 0x22800
    s_nop 0
    buffer_load_dwordx4 v26, s[28:31], s78 offen lds
    v_mfma_f32_32x32x16_bf16 v[64:79], v[160:163], v[32:35], v[64:79]
    ds_read_b128 v[176:179], v13 offset:49152
    ds_read_b64_tr_b16 v[48:49], v4 offset:36992
    ds_read_b64_tr_b16 v[50:51], v4 offset:37760
    v_mfma_f32_32x32x16_bf16 v[64:79], v[164:167], v[36:39], v[64:79]
    ds_read_b128 v[180:183], v14 offset:49152
    ds_read_b64_tr_b16 v[52:53], v4 offset:40064
    ds_read_b64_tr_b16 v[54:55], v4 offset:40832
    v_mfma_f32_32x32x16_bf16 v[64:79], v[168:171], v[40:43], v[64:79]
    ds_read_b128 v[184:187], v15 offset:49152
    ds_read_b64_tr_b16 v[56:57], v4 offset:43136
    ds_read_b64_tr_b16 v[58:59], v4 offset:43904
    v_mfma_f32_32x32x16_bf16 v[64:79], v[172:175], v[44:47], v[64:79]
    ds_read_b128 v[188:191], v1 offset:49152
    ds_read_b64_tr_b16 v[60:61], v4 offset:46208
    ds_read_b64_tr_b16 v[62:63], v4 offset:46976
    v_and_b32 v28, 15, v0
    v_lshrrev_b32 v29, 5, v0
    v_lshl_add_u32 v28, v29, 4, v28
    v_lshlrev_b32 v28, 4, v28
    v_bfe_u32 v29, v0, 4, 1
    v_lshl_add_u32 v11, v29, 16, v28
    s_set_gpr_idx_on s68, gpr_idx(SRC0)
    v_dot2c_f32_bf16 v16, v32, v27
    v_dot2c_f32_bf16 v17, v36, v27
    v_dot2c_f32_bf16 v16, v40, v27
    v_dot2c_f32_bf16 v17, v44, v27
    s_set_gpr_idx_off
    v_dot2_f32_bf16 v100, v160, v27, v100
    v_dot2_f32_bf16 v102, v160, v160, v102
    v_dot2_f32_bf16 v101, v161, v27, v101
    v_dot2_f32_bf16 v103, v161, v161, v103
    v_dot2_f32_bf16 v100, v162, v27, v100
    v_dot2_f32_bf16 v102, v162, v162, v102
    v_dot2_f32_bf16 v101, v163, v27, v101
    v_dot2_f32_bf16 v103, v163, v163, v103
    v_dot2_f32_bf16 v100, v164, v27, v100
    v_dot2_f32_bf16 v102, v164, v164, v102
    v_dot2_f32_bf16 v101, v165, v27, v101
    v_dot2_f32_bf16 v103, v165, v165, v103
    v_dot2_f32_bf16 v100, v166, v27, v100
    v_dot2_f32_bf16 v102, v166, v166, v102
    v_dot2_f32_bf16 v101, v167, v27, v101
    v_dot2_f32_bf16 v103, v167, v167, v103
    v_dot2_f32_bf16 v100, v168, v27, v100
    v_dot2_f32_bf16 v102, v168, v168, v102
    v_dot2_f32_bf16 v101, v169, v27, v101
    v_dot2_f32_bf16 v103, v169, v169, v103
    v_dot2_f32_bf16 v100, v170, v27, v100
    v_dot2_f32_bf16 v102, v170, v170, v102
    v_dot2_f32_bf16 v101, v171, v27, v101
    v_dot2_f32_bf16 v103, v171, v171, v103
    v_dot2_f32_bf16 v100, v172, v27, v100
    v_dot2_f32_bf16 v102, v172, v172, v102
    v_dot2_f32_bf16 v101, v173, v27, v101
    v_dot2_f32_bf16 v103, v173, v173, v103
    v_dot2_f32_bf16 v100, v174, v27, v100
    v_dot2_f32_bf16 v102, v174, v174, v102
    v_dot2_f32_bf16 v101, v175, v27, v101
    v_dot2_f32_bf16 v103, v175, v175, v103
    s_waitcnt vmcnt(6)
    s_waitcnt lgkmcnt(0)
    s_barrier
    s_add_u32 m0, s71, 0x25000
    s_add_u32 s78, s20, 7
    s_and_b32 s78, s78, 7
    s_mul_i32 s78, s78, 0x30000
    buffer_load_dwordx4 v24, s[28:31], s78 offen lds
    s_add_u32 m0, s71, 0x25400
    s_nop 0
    buffer_load_dwordx4 v25, s[28:31], s78 offen lds
    s_add_u32 m0, s71, 0x25800
    s_nop 0
    buffer_load_dwordx4 v26, s[28:31], s78 offen lds
    v_mfma_f32_32x32x16_bf16 v[64:79], v[176:179], v[48:51], v[64:79]
    ds_read_b128 v[192:195], v13 offset:0
    ds_read_b64_tr_b16 v[32:33], v5 offset:128
    ds_read_b64_tr_b16 v[34:35], v5 offset:896
    v_mfma_f32_32x32x16_bf16 v[64:79], v[180:183], v[52:55], v[64:79]
    ds_read_b128 v[196:199], v14 offset:0
    ds_read_b64_tr_b16 v[36:37], v5 offset:3200
    ds_read_b64_tr_b16 v[38:39], v5 offset:3968
    v_mfma_f32_32x32x16_bf16 v[64:79], v[184:187], v[56:59], v[64:79]
    ds_read_b128 v[200:203], v15 offset:0
    ds_read_b64_tr_b16 v[40:41], v5 offset:6272
    ds_read_b64_tr_b16 v[42:43], v5 offset:7040
    v_mfma_f32_32x32x16_bf16 v[64:79], v[188:191], v[60:63], v[64:79]
    ds_read_b128 v[204:207], v1 offset:0
    ds_read_b64_tr_b16 v[44:45], v5 offset:9344
    ds_read_b64_tr_b16 v[46:47], v5 offset:10112
    s_mov_b32 s44, s16
    s_mov_b32 s45, s17
    s_mov_b32 s46, 0x1c0000
    s_mov_b32 s47, 0x20000
    s_mov_b32 s32, s8
    s_mov_b32 s33, s9
    s_mov_b32 s34, 0x80000
    s_mov_b32 s35, 0x20000
    s_mov_b32 s48, s18
    s_mov_b32 s49, s19
    s_mov_b32 s50, 0x200000
    s_mov_b32 s51, 0x20000
    s_and_b32 s64, s59, 3
    s_mul_i32 s64, s64, 7
    s_lshr_b32 s65, s59, 2
    s_min_u32 s65, s65, 6
    s_add_u32 s10, s64, s65
    s_lshl_b32 s64, s59, 16
    s_add_u32 s77, s64, s75
    s_set_gpr_idx_on s68, gpr_idx(SRC0)
    v_dot2c_f32_bf16 v16, v48, v27
    v_dot2c_f32_bf16 v17, v52, v27
    v_dot2c_f32_bf16 v16, v56, v27
    v_dot2c_f32_bf16 v17, v60, v27
    s_set_gpr_idx_off
    v_dot2_f32_bf16 v100, v176, v27, v100
    v_dot2_f32_bf16 v102, v176, v176, v102
    v_dot2_f32_bf16 v101, v177, v27, v101
    v_dot2_f32_bf16 v103, v177, v177, v103
    v_dot2_f32_bf16 v100, v178, v27, v100
    v_dot2_f32_bf16 v102, v178, v178, v102
    v_dot2_f32_bf16 v101, v179, v27, v101
    v_dot2_f32_bf16 v103, v179, v179, v103
    v_dot2_f32_bf16 v100, v180, v27, v100
    v_dot2_f32_bf16 v102, v180, v180, v102
    v_dot2_f32_bf16 v101, v181, v27, v101
    v_dot2_f32_bf16 v103, v181, v181, v103
    v_dot2_f32_bf16 v100, v182, v27, v100
    v_dot2_f32_bf16 v102, v182, v182, v102
    v_dot2_f32_bf16 v101, v183, v27, v101
    v_dot2_f32_bf16 v103, v183, v183, v103
    v_dot2_f32_bf16 v100, v184, v27, v100
    v_dot2_f32_bf16 v102, v184, v184, v102
    v_dot2_f32_bf16 v101, v185, v27, v101
    v_dot2_f32_bf16 v103, v185, v185, v103
    v_dot2_f32_bf16 v100, v186, v27, v100
    v_dot2_f32_bf16 v102, v186, v186, v102
    v_dot2_f32_bf16 v101, v187, v27, v101
    v_dot2_f32_bf16 v103, v187, v187, v103
    v_dot2_f32_bf16 v100, v188, v27, v100
    v_dot2_f32_bf16 v102, v188, v188, v102
    v_dot2_f32_bf16 v101, v189, v27, v101
    v_dot2_f32_bf16 v103, v189, v189, v103
    v_dot2_f32_bf16 v100, v190, v27, v100
    v_dot2_f32_bf16 v102, v190, v190, v102
    v_dot2_f32_bf16 v101, v191, v27, v101
    v_dot2_f32_bf16 v103, v191, v191, v103
    s_waitcnt vmcnt(6)
    s_waitcnt lgkmcnt(0)
    s_barrier
    v_mov_b32 v23, 0
    buffer_load_dword v23, v23, s[52:55], 0 offen offset:0 sc1
    s_cmp_ge_u32 s11, 14
    s_cbranch_scc1 L_idle_19
    s_add_u32 m0, s75, 0x10000
    s_add_u32 s64, s74, 0
    s_and_b32 s64, s64, 31
    s_mul_i32 s64, s64, 0xe000
    buffer_load_dwordx4 v12, s[84:87], s64 offen lds
    s_add_u32 m0, s75, 0x12000
    s_add_u32 s64, s74, 1
    s_and_b32 s64, s64, 31
    s_mul_i32 s64, s64, 0xe000
    buffer_load_dwordx4 v12, s[84:87], s64 offen lds
    s_add_u32 m0, s75, 0x14000
    s_add_u32 s64, s74, 2
    s_and_b32 s64, s64, 31
    s_mul_i32 s64, s64, 0xe000
    buffer_load_dwordx4 v12, s[84:87], s64 offen lds
    s_add_u32 m0, s75, 0
    s_add_u32 s64, s74, 3
    s_and_b32 s64, s64, 31
    s_mul_i32 s64, s64, 0xe000
    buffer_load_dwordx4 v12, s[84:87], s64 offen lds
    s_add_u32 m0, s75, 0x2000
    s_add_u32 s64, s74, 4
    s_and_b32 s64, s64, 31
    s_mul_i32 s64, s64, 0xe000
    buffer_load_dwordx4 v12, s[84:87], s64 offen lds
    s_branch L_done_20
L_idle_19:
    s_mov_b32 s64, 0
    buffer_load_dwordx4 v[128:131], v12, s[84:87], s64 offen
    s_mov_b32 s64, 0x7000
    buffer_load_dwordx4 v[132:135], v12, s[84:87], s64 offen
    s_mov_b32 s64, 0xe000
    buffer_load_dwordx4 v[136:139], v12, s[84:87], s64 offen
    s_mov_b32 s64, 0x15000
    buffer_load_dwordx4 v[140:143], v12, s[84:87], s64 offen
L_done_20:
    v_mfma_f32_32x32x16_bf16 v[64:79], v[192:195], v[32:35], v[64:79]
    ds_read_b128 v[208:211], v13 offset:16384
    ds_read_b64_tr_b16 v[48:49], v5 offset:12416
    ds_read_b64_tr_b16 v[50:51], v5 offset:13184
    v_mfma_f32_32x32x16_bf16 v[64:79], v[196:199], v[36:39], v[64:79]
    ds_read_b128 v[212:215], v14 offset:16384
    ds_read_b64_tr_b16 v[52:53], v5 offset:15488
    ds_read_b64_tr_b16 v[54:55], v5 offset:16256
    v_mfma_f32_32x32x16_bf16 v[64:79], v[200:203], v[40:43], v[64:79]
    ds_read_b128 v[216:219], v15 offset:16384
    ds_read_b64_tr_b16 v[56:57], v5 offset:18560
    ds_read_b64_tr_b16 v[58:59], v5 offset:19328
    v_mfma_f32_32x32x16_bf16 v[64:79], v[204:207], v[44:47], v[64:79]
    ds_read_b128 v[220:223], v1 offset:16384
    ds_read_b64_tr_b16 v[60:61], v5 offset:21632
    ds_read_b64_tr_b16 v[62:63], v5 offset:22400
    s_set_gpr_idx_on s68, gpr_idx(SRC0)
    v_dot2c_f32_bf16 v16, v32, v27
    v_dot2c_f32_bf16 v17, v36, v27
    v_dot2c_f32_bf16 v16, v40, v27
    v_dot2c_f32_bf16 v17, v44, v27
    s_set_gpr_idx_off
    v_dot2_f32_bf16 v100, v192, v27, v100
    v_dot2_f32_bf16 v102, v192, v192, v102
    v_dot2_f32_bf16 v101, v193, v27, v101
    v_dot2_f32_bf16 v103, v193, v193, v103
    v_dot2_f32_bf16 v100, v194, v27, v100
    v_dot2_f32_bf16 v102, v194, v194, v102
    v_dot2_f32_bf16 v101, v195, v27, v101
    v_dot2_f32_bf16 v103, v195, v195, v103
    v_dot2_f32_bf16 v100, v196, v27, v100
    v_dot2_f32_bf16 v102, v196, v196, v102
    v_dot2_f32_bf16 v101, v197, v27, v101
    v_dot2_f32_bf16 v103, v197, v197, v103
    v_dot2_f32_bf16 v100, v198, v27, v100
    v_dot2_f32_bf16 v102, v198, v198, v102
    v_dot2_f32_bf16 v101, v199, v27, v101
    v_dot2_f32_bf16 v103, v199, v199, v103
    v_dot2_f32_bf16 v100, v200, v27, v100
    v_dot2_f32_bf16 v102, v200, v200, v102
    v_dot2_f32_bf16 v101, v201, v27, v101
    v_dot2_f32_bf16 v103, v201, v201, v103
    v_dot2_f32_bf16 v100, v202, v27, v100
    v_dot2_f32_bf16 v102, v202, v202, v102
    v_dot2_f32_bf16 v101, v203, v27, v101
    v_dot2_f32_bf16 v103, v203, v203, v103
    v_dot2_f32_bf16 v100, v204, v27, v100
    v_dot2_f32_bf16 v102, v204, v204, v102
    v_dot2_f32_bf16 v101, v205, v27, v101
    v_dot2_f32_bf16 v103, v205, v205, v103
    v_dot2_f32_bf16 v100, v206, v27, v100
    v_dot2_f32_bf16 v102, v206, v206, v102
    v_dot2_f32_bf16 v101, v207, v27, v101
    v_dot2_f32_bf16 v103, v207, v207, v103
    s_waitcnt vmcnt(8)
    s_waitcnt lgkmcnt(0)
    s_barrier
    s_cmp_ge_u32 s11, 14
    s_cbranch_scc1 L_idle_21
    s_add_u32 m0, s75, 0x4000
    s_add_u32 s64, s74, 5
    s_and_b32 s64, s64, 31
    s_mul_i32 s64, s64, 0xe000
    buffer_load_dwordx4 v12, s[84:87], s64 offen lds
    s_add_u32 m0, s75, 0x6000
    s_add_u32 s64, s74, 6
    s_and_b32 s64, s64, 31
    s_mul_i32 s64, s64, 0xe000
    buffer_load_dwordx4 v12, s[84:87], s64 offen lds
    s_branch L_done_22
L_idle_21:
    s_mov_b32 s64, 0x1c000
    buffer_load_dwordx4 v[144:147], v12, s[84:87], s64 offen
    s_mov_b32 s64, 0x23000
    buffer_load_dwordx4 v[148:151], v12, s[84:87], s64 offen
    s_mov_b32 s64, 0x2a000
    buffer_load_dwordx4 v[152:155], v12, s[84:87], s64 offen
    s_mov_b32 s64, 0x31000
    buffer_load_dwordx4 v[156:159], v12, s[84:87], s64 offen
L_done_22:
    v_mfma_f32_32x32x16_bf16 v[64:79], v[208:211], v[48:51], v[64:79]
    ds_read_b128 v[224:227], v13 offset:32768
    ds_read_b64_tr_b16 v[32:33], v5 offset:24704
    ds_read_b64_tr_b16 v[34:35], v5 offset:25472
    v_mfma_f32_32x32x16_bf16 v[64:79], v[212:215], v[52:55], v[64:79]
    ds_read_b128 v[228:231], v14 offset:32768
    ds_read_b64_tr_b16 v[36:37], v5 offset:27776
    ds_read_b64_tr_b16 v[38:39], v5 offset:28544
    v_mfma_f32_32x32x16_bf16 v[64:79], v[216:219], v[56:59], v[64:79]
    ds_read_b128 v[232:235], v15 offset:32768
    ds_read_b64_tr_b16 v[40:41], v5 offset:30848
    ds_read_b64_tr_b16 v[42:43], v5 offset:31616
    v_mfma_f32_32x32x16_bf16 v[64:79], v[220:223], v[60:63], v[64:79]
    ds_read_b128 v[236:239], v1 offset:32768
    ds_read_b64_tr_b16 v[44:45], v5 offset:33920
    ds_read_b64_tr_b16 v[46:47], v5 offset:34688
    s_set_gpr_idx_on s68, gpr_idx(SRC0)
    v_dot2c_f32_bf16 v16, v48, v27
    v_dot2c_f32_bf16 v17, v52, v27
    v_dot2c_f32_bf16 v16, v56, v27
    v_dot2c_f32_bf16 v17, v60, v27
    s_set_gpr_idx_off
    v_dot2_f32_bf16 v100, v208, v27, v100
    v_dot2_f32_bf16 v102, v208, v208, v102
    v_dot2_f32_bf16 v101, v209, v27, v101
    v_dot2_f32_bf16 v103, v209, v209, v103
    v_dot2_f32_bf16 v100, v210, v27, v100
    v_dot2_f32_bf16 v102, v210, v210, v102
    v_dot2_f32_bf16 v101, v211, v27, v101
    v_dot2_f32_bf16 v103, v211, v211, v103
    v_dot2_f32_bf16 v100, v212, v27, v100
    v_dot2_f32_bf16 v102, v212, v212, v102
    v_dot2_f32_bf16 v101, v213, v27, v101
    v_dot2_f32_bf16 v103, v213, v213, v103
    v_dot2_f32_bf16 v100, v214, v27, v100
    v_dot2_f32_bf16 v102, v214, v214, v102
    v_dot2_f32_bf16 v101, v215, v27, v101
    v_dot2_f32_bf16 v103, v215, v215, v103
    v_dot2_f32_bf16 v100, v216, v27, v100
    v_dot2_f32_bf16 v102, v216, v216, v102
    v_dot2_f32_bf16 v101, v217, v27, v101
    v_dot2_f32_bf16 v103, v217, v217, v103
    v_dot2_f32_bf16 v100, v218, v27, v100
    v_dot2_f32_bf16 v102, v218, v218, v102
    v_dot2_f32_bf16 v101, v219, v27, v101
    v_dot2_f32_bf16 v103, v219, v219, v103
    v_dot2_f32_bf16 v100, v220, v27, v100
    v_dot2_f32_bf16 v102, v220, v220, v102
    v_dot2_f32_bf16 v101, v221, v27, v101
    v_dot2_f32_bf16 v103, v221, v221, v103
    v_dot2_f32_bf16 v100, v222, v27, v100
    v_dot2_f32_bf16 v102, v222, v222, v102
    v_dot2_f32_bf16 v101, v223, v27, v101
    v_dot2_f32_bf16 v103, v223, v223, v103
    s_waitcnt vmcnt(8)
    s_waitcnt lgkmcnt(0)
    s_barrier
    s_cmp_ge_u32 s11, 14
    s_cbranch_scc1 L_idle_23
    s_add_u32 m0, s75, 0x8000
    s_add_u32 s64, s74, 7
    s_and_b32 s64, s64, 31
    s_mul_i32 s64, s64, 0xe000
    buffer_load_dwordx4 v12, s[84:87], s64 offen lds
    s_add_u32 m0, s75, 0xa000
    s_add_u32 s64, s74, 8
    s_and_b32 s64, s64, 31
    s_mul_i32 s64, s64, 0xe000
    buffer_load_dwordx4 v12, s[84:87], s64 offen lds
    s_add_u32 m0, s75, 0x18000
    s_add_u32 s64, s74, 11
    s_and_b32 s64, s64, 31
    s_mul_i32 s64, s64, 0xe000
    buffer_load_dwordx4 v12, s[84:87], s64 offen lds
    s_add_u32 m0, s75, 0x1a000
    s_add_u32 s64, s74, 12
    s_and_b32 s64, s64, 31
    s_mul_i32 s64, s64, 0xe000
    buffer_load_dwordx4 v12, s[84:87], s64 offen lds
    s_branch L_done_24
L_idle_23:
    s_mov_b32 s64, 0x38000
    buffer_load_dwordx4 v[160:163], v12, s[84:87], s64 offen
    s_mov_b32 s64, 0x3f000
    buffer_load_dwordx4 v[164:167], v12, s[84:87], s64 offen
    s_mov_b32 s64, 0x46000
    buffer_load_dwordx4 v[168:171], v12, s[84:87], s64 offen
    s_mov_b32 s64, 0x4d000
    buffer_load_dwordx4 v[172:175], v12, s[84:87], s64 offen
L_done_24:
    v_mfma_f32_32x32x16_bf16 v[64:79], v[224:227], v[32:35], v[64:79]
    ds_read_b128 v[240:243], v13 offset:49152
    ds_read_b64_tr_b16 v[48:49], v5 offset:36992
    ds_read_b64_tr_b16 v[50:51], v5 offset:37760
    v_mfma_f32_32x32x16_bf16 v[64:79], v[228:231], v[36:39], v[64:79]
    ds_read_b128 v[244:247], v14 offset:49152
    ds_read_b64_tr_b16 v[52:53], v5 offset:40064
    ds_read_b64_tr_b16 v[54:55], v5 offset:40832
    v_mfma_f32_32x32x16_bf16 v[64:79], v[232:235], v[40:43], v[64:79]
    ds_read_b128 v[248:251], v15 offset:49152
    ds_read_b64_tr_b16 v[56:57], v5 offset:43136
    ds_read_b64_tr_b16 v[58:59], v5 offset:43904
    v_mfma_f32_32x32x16_bf16 v[64:79], v[236:239], v[44:47], v[64:79]
    ds_read_b128 v[252:255], v1 offset:49152
    ds_read_b64_tr_b16 v[60:61], v5 offset:46208
    ds_read_b64_tr_b16 v[62:63], v5 offset:46976
    s_set_gpr_idx_on s68, gpr_idx(SRC0)
    v_dot2c_f32_bf16 v16, v32, v27
    v_dot2c_f32_bf16 v17, v36, v27
    v_dot2c_f32_bf16 v16, v40, v27
    v_dot2c_f32_bf16 v17, v44, v27
    s_set_gpr_idx_off
    v_dot2_f32_bf16 v100, v224, v27, v100
    v_dot2_f32_bf16 v102, v224, v224, v102
    v_dot2_f32_bf16 v101, v225, v27, v101
    v_dot2_f32_bf16 v103, v225, v225, v103
    v_dot2_f32_bf16 v100, v226, v27, v100
    v_dot2_f32_bf16 v102, v226, v226, v102
    v_dot2_f32_bf16 v101, v227, v27, v101
    v_dot2_f32_bf16 v103, v227, v227, v103
    v_dot2_f32_bf16 v100, v228, v27, v100
    v_dot2_f32_bf16 v102, v228, v228, v102
    v_dot2_f32_bf16 v101, v229, v27, v101
    v_dot2_f32_bf16 v103, v229, v229, v103
    v_dot2_f32_bf16 v100, v230, v27, v100
    v_dot2_f32_bf16 v102, v230, v230, v102
    v_dot2_f32_bf16 v101, v231, v27, v101
    v_dot2_f32_bf16 v103, v231, v231, v103
    v_dot2_f32_bf16 v100, v232, v27, v100
    v_dot2_f32_bf16 v102, v232, v232, v102
    v_dot2_f32_bf16 v101, v233, v27, v101
    v_dot2_f32_bf16 v103, v233, v233, v103
    v_dot2_f32_bf16 v100, v234, v27, v100
    v_dot2_f32_bf16 v102, v234, v234, v102
    v_dot2_f32_bf16 v101, v235, v27, v101
    v_dot2_f32_bf16 v103, v235, v235, v103
    v_dot2_f32_bf16 v100, v236, v27, v100
    v_dot2_f32_bf16 v102, v236, v236, v102
    v_dot2_f32_bf16 v101, v237, v27, v101
    v_dot2_f32_bf16 v103, v237, v237, v103
    v_dot2_f32_bf16 v100, v238, v27, v100
    v_dot2_f32_bf16 v102, v238, v238, v102
    v_dot2_f32_bf16 v101, v239, v27, v101
    v_dot2_f32_bf16 v103, v239, v239, v103
    s_cmp_ge_u32 s11, 14
    s_cbranch_scc1 L_idle_25
    s_add_u32 m0, s75, 0x1c000
    s_add_u32 s64, s74, 13
    s_and_b32 s64, s64, 31
    s_mul_i32 s64, s64, 0xe000
    buffer_load_dwordx4 v12, s[84:87], s64 offen lds
    s_add_u32 m0, s75, 0x1e000
    s_add_u32 s64, s74, 14
    s_and_b32 s64, s64, 31
    s_mul_i32 s64, s64, 0xe000
    buffer_load_dwordx4 v12, s[84:87], s64 offen lds
    s_branch L_done_26
L_idle_25:
    s_mov_b32 s64, 0x54000
    buffer_load_dwordx4 v[176:179], v12, s[84:87], s64 offen
    s_mov_b32 s64, 0x5b000
    buffer_load_dwordx4 v[180:183], v12, s[84:87], s64 offen
    s_mov_b32 s64, 0x62000
    buffer_load_dwordx4 v[184:187], v12, s[84:87], s64 offen
    s_mov_b32 s64, 0x69000
    buffer_load_dwordx4 v[188:191], v12, s[84:87], s64 offen
L_done_26:
    s_set_gpr_idx_on s68, gpr_idx(SRC0)
    s_waitcnt lgkmcnt(9)
    v_dot2c_f32_bf16 v16, v48, v27
    s_waitcnt lgkmcnt(6)
    v_dot2c_f32_bf16 v17, v52, v27
    s_waitcnt lgkmcnt(3)
    v_dot2c_f32_bf16 v16, v56, v27
    s_waitcnt lgkmcnt(0)
    v_dot2c_f32_bf16 v17, v60, v27
    s_set_gpr_idx_off
    v_dot2_f32_bf16 v100, v240, v27, v100
    v_dot2_f32_bf16 v102, v240, v240, v102
    v_dot2_f32_bf16 v101, v241, v27, v101
    v_dot2_f32_bf16 v103, v241, v241, v103
    v_dot2_f32_bf16 v100, v242, v27, v100
    v_dot2_f32_bf16 v102, v242, v242, v102
    v_dot2_f32_bf16 v101, v243, v27, v101
    v_dot2_f32_bf16 v103, v243, v243, v103
    v_dot2_f32_bf16 v100, v244, v27, v100
    v_dot2_f32_bf16 v102, v244, v244, v102
    v_dot2_f32_bf16 v101, v245, v27, v101
    v_dot2_f32_bf16 v103, v245, v245, v103
    v_dot2_f32_bf16 v100, v246, v27, v100
    v_dot2_f32_bf16 v102, v246, v246, v102
    v_dot2_f32_bf16 v101, v247, v27, v101
    v_dot2_f32_bf16 v103, v247, v247, v103
    v_dot2_f32_bf16 v100, v248, v27, v100
    v_dot2_f32_bf16 v102, v248, v248, v102
    v_dot2_f32_bf16 v101, v249, v27, v101
    v_dot2_f32_bf16 v103, v249, v249, v103
    v_dot2_f32_bf16 v100, v250, v27, v100
    v_dot2_f32_bf16 v102, v250, v250, v102
    v_dot2_f32_bf16 v101, v251, v27, v101
    v_dot2_f32_bf16 v103, v251, v251, v103
    v_dot2_f32_bf16 v100, v252, v27, v100
    v_dot2_f32_bf16 v102, v252, v252, v102
    v_dot2_f32_bf16 v101, v253, v27, v101
    v_dot2_f32_bf16 v103, v253, v253, v103
    v_dot2_f32_bf16 v100, v254, v27, v100
    v_dot2_f32_bf16 v102, v254, v254, v102
    v_dot2_f32_bf16 v101, v255, v27, v101
    v_dot2_f32_bf16 v103, v255, v255, v103
    v_and_b32 v21, 31, v0
    s_lshl_b32 s64, s68, 7
    s_add_u32 s66, s64, 0x16000
    v_lshl_add_u32 v20, v21, 2, s66
    v_lshlrev_b32 v21, 2, v21
    v_add_u32 v21, 0x16a00, v21
    v_add_f32 v100, v100, v101
    v_mov_b32 v101, v100
    s_nop 1
    v_permlane32_swap_b32 v100, v101
    v_add_f32 v100, v100, v101
    v_add_f32 v102, v102, v103
    v_mov_b32 v103, v102
    s_nop 1
    v_permlane32_swap_b32 v102, v103
    v_add_f32 v102, v102, v103
    v_mul_f32 v28, 0xbb000000, v100
    v_mul_f32 v102, 0x3b000000, v102
    v_fma_f32 v102, -v28, v28, v102
    v_max_f32 v102, 0, v102
    v_add_f32 v2, 0x3727c5ac, v102
    v_rsq_f32 v3, v2
    ds_write_b32 v20, v28 offset:1024
    ds_write_b32 v20, v2 offset:512
    ds_write_b32 v20, v3
    v_add_f32 v16, v16, v17
    v_mov_b32 v17, v16
    s_nop 1
    v_permlane32_swap_b32 v16, v17
    v_add_f32 v16, v16, v17
    ds_write_b32 v20, v16 offset:2560
    v_and_b32 v104, s61, v28
    v_sub_f32 v105, v28, v104
    v_cvt_pk_bf16_f32 v16, v104, v105
    v_cvt_pk_bf16_f32 v17, v104, 0
    v_and_b32 v16, v22, v16
    v_and_b32 v17, v22, v17
    v_mov_b32 v18, 0
    v_mov_b32 v19, 0
    v_mfma_f32_32x32x16_bf16 v[64:79], v[240:243], v[48:51], v[64:79]
    v_mfma_f32_32x32x16_bf16 v[64:79], v[244:247], v[52:55], v[64:79]
    v_mfma_f32_32x32x16_bf16 v[64:79], v[248:251], v[56:59], v[64:79]
    v_mfma_f32_32x32x16_bf16 v[64:79], v[252:255], v[60:63], v[64:79]
    s_setprio 0
    s_waitcnt vmcnt(13)
    v_readfirstlane_b32 s63, v23
    s_waitcnt vmcnt(9)
    s_waitcnt lgkmcnt(0)
    s_barrier
    s_mul_i32 s63, s63, 0x9e3779b1
    s_add_u32 s63, s63, 0x7f4a7c15
    v_mov_b32 v1, v12
    v_mov_b32 v5, v22
    ds_read_b32 v24, v21 offset:0
    ds_read_b32 v25, v21 offset:128
    ds_read_b32 v26, v21 offset:256
    ds_read_b32 v27, v21 offset:384
    v_lshrrev_b32 v23, 5, v0
    v_lshl_add_u32 v23, v23, 4, s66
    ds_read_b128 v[80:83], v23 offset:0
    ds_read_b128 v[84:87], v23 offset:32
    ds_read_b128 v[88:91], v23 offset:64
    ds_read_b128 v[92:95], v23 offset:96
    v_add_u32 v8, 0x10000, v8
    ds_read_b64_tr_b16 v[32:33], v8 offset:0
    ds_read_b64_tr_b16 v[34:35], v8 offset:1024
    v_add_u32 v9, 0x10000, v9
    ds_read_b64_tr_b16 v[36:37], v9 offset:0
    ds_read_b64_tr_b16 v[38:39], v9 offset:1024
    ds_read_b64_tr_b16 v[40:41], v8 offset:8192
    ds_read_b64_tr_b16 v[42:43], v8 offset:9216
    ds_read_b64_tr_b16 v[44:45], v9 offset:8192
    ds_read_b64_tr_b16 v[46:47], v9 offset:9216
    ds_read_b64_tr_b16 v[48:49], v8 offset:16384
    ds_read_b64_tr_b16 v[50:51], v8 offset:17408
    ds_read_b64_tr_b16 v[52:53], v9 offset:16384
    ds_read_b64_tr_b16 v[54:55], v9 offset:17408
    s_cmp_ge_u32 s11, 14
    s_cbranch_scc1 L_idle_27
    s_add_u32 m0, s75, 0xc000
    s_add_u32 s64, s74, 9
    s_and_b32 s64, s64, 31
    s_mul_i32 s64, s64, 0xe000
    buffer_load_dwordx4 v1, s[84:87], s64 offen lds
    s_add_u32 m0, s75, 0xe000
    s_add_u32 s64, s74, 10
    s_and_b32 s64, s64, 31
    s_mul_i32 s64, s64, 0xe000
    buffer_load_dwordx4 v1, s[84:87], s64 offen lds
    s_branch L_done_28
L_idle_27:
L_done_28:
    s_lshl_b32 s64, s57, 2
    s_add_u32 s67, s64, s68
    s_lshl_b32 s64, s67, 10
    s_lshr_b32 s65, s58, 1
    s_lshl_b32 s65, s65, 18
    s_add_u32 s66, s64, s65
    s_waitcnt lgkmcnt(10)
    v_mfma_f32_32x32x16_bf16 v[96:111], v[32:35], v[128:131], 0
    v_add_u32 v8, 0xffff0000, v8
    ds_read_b64_tr_b16 v[56:57], v8 offset:0
    ds_read_b64_tr_b16 v[58:59], v8 offset:1024
    v_add_f32 v24, v24, v25
    v_add_f32 v26, v26, v27
    v_add_f32 v24, v24, v26
    v_and_b32 v29, s61, v24
    v_sub_f32 v30, v24, v29
    v_cvt_pk_bf16_f32 v24, v29, v29
    s_waitcnt lgkmcnt(10)
    v_mfma_f32_32x32x16_bf16 v[112:127], v[36:39], v[128:131], 0
    v_add_u32 v9, 0xffff0000, v9
    ds_read_b64_tr_b16 v[60:61], v9 offset:0
    ds_read_b64_tr_b16 v[62:63], v9 offset:1024
    v_cvt_pk_bf16_f32 v25, v30, 0
    v_and_b32 v24, v5, v24
    v_and_b32 v25, v5, v25
    v_mov_b32 v26, 0
    v_mov_b32 v27, 0
    s_nop 1
    v_mfma_f32_32x32x16_bf16 v[64:79], v[16:19], v[24:27], v[64:79]
    s_waitcnt lgkmcnt(10)
    v_mfma_f32_32x32x16_bf16 v[96:111], v[40:43], v[132:135], v[96:111]
    v_add_u32 v6, 0x10000, v6
    ds_read_b64_tr_b16 v[32:33], v6 offset:0
    ds_read_b64_tr_b16 v[34:35], v6 offset:1024
    s_nop 6
    v_mul_f32 v64, v80, v64
    v_mul_f32 v65, v81, v65
    v_mul_f32 v66, v82, v66
    v_mul_f32 v67, v83, v67
    v_mul_f32 v68, v84, v68
    v_mul_f32 v69, v85, v69
    s_waitcnt lgkmcnt(10)
    v_mfma_f32_32x32x16_bf16 v[112:127], v[44:47], v[132:135], v[112:127]
    v_add_u32 v7, 0x10000, v7
    ds_read_b64_tr_b16 v[36:37], v7 offset:0
    ds_read_b64_tr_b16 v[38:39], v7 offset:1024
    v_mul_f32 v70, v86, v70
    v_mul_f32 v71, v87, v71
    v_mul_f32 v72, v88, v72
    v_mul_f32 v73, v89, v73
    v_mul_f32 v74, v90, v74
    v_mul_f32 v75, v91, v75
    s_waitcnt lgkmcnt(10)
    v_mfma_f32_32x32x16_bf16 v[96:111], v[48:51], v[136:139], v[96:111]
    ds_read_b64_tr_b16 v[40:41], v6 offset:8192
    ds_read_b64_tr_b16 v[42:43], v6 offset:9216
    v_mul_f32 v76, v92, v76
    v_mul_f32 v77, v93, v77
    v_mul_f32 v78, v94, v78
    v_mul_f32 v79, v95, v79
    v_cvt_pk_bf16_f32 v12, v64, v65
    v_cvt_pk_bf16_f32 v13, v66, v67
    s_waitcnt lgkmcnt(10)
    v_mfma_f32_32x32x16_bf16 v[112:127], v[52:55], v[136:139], v[112:127]
    ds_read_b64_tr_b16 v[44:45], v7 offset:8192
    ds_read_b64_tr_b16 v[46:47], v7 offset:9216
    v_cvt_pk_bf16_f32 v14, v68, v69
    v_cvt_pk_bf16_f32 v15, v70, v71
    v_cvt_pk_bf16_f32 v20, v72, v73
    v_cvt_pk_bf16_f32 v21, v74, v75
    v_cvt_pk_bf16_f32 v22, v76, v77
    v_cvt_pk_bf16_f32 v23, v78, v79
    s_waitcnt lgkmcnt(10)
    v_mfma_f32_32x32x16_bf16 v[96:111], v[56:59], v[140:143], v[96:111]
    ds_read_b64_tr_b16 v[48:49], v6 offset:16384
    ds_read_b64_tr_b16 v[50:51], v6 offset:17408
    s_lshl_b32 s64, s82, 17
    s_add_u32 s64, s64, s66
    s_add_u32 s66, s64, 0x460000
    v_mul_f32 v3, 0xbfb8aa3b, v3
    s_waitcnt lgkmcnt(10)
    v_mfma_f32_32x32x16_bf16 v[112:127], v[60:63], v[140:143], v[112:127]
    ds_read_b64_tr_b16 v[52:53], v7 offset:16384
    ds_read_b64_tr_b16 v[54:55], v7 offset:17408
L_up:
    s_cmp_ge_u32 s11, 14
    s_cbranch_scc1 L_noup
    s_setprio 1
    s_waitcnt lgkmcnt(10)
    v_mfma_f32_32x32x16_bf16 v[64:79], v[32:35], v[128:131], 0
    v_add_u32 v6, 0xffff0000, v6
    ds_read_b64_tr_b16 v[56:57], v6 offset:0
    ds_read_b64_tr_b16 v[58:59], v6 offset:1024
    s_waitcnt lgkmcnt(10)
    v_mfma_f32_32x32x16_bf16 v[80:95], v[36:39], v[128:131], 0
    v_add_u32 v7, 0xffff0000, v7
    ds_read_b64_tr_b16 v[60:61], v7 offset:0
    ds_read_b64_tr_b16 v[62:63], v7 offset:1024
    s_cmp_ge_u32 s56, 4
    s_cbranch_scc0 L_only_29
    buffer_store_dwordx4 v[12:15], v11, s[52:55], s66 offen offset:0 sc1
L_only_29:
    s_waitcnt lgkmcnt(10)
    v_mfma_f32_32x32x16_bf16 v[64:79], v[40:43], v[132:135], v[64:79]
    s_waitcnt lgkmcnt(8)
    v_mfma_f32_32x32x16_bf16 v[80:95], v[44:47], v[132:135], v[80:95]
    s_cmp_ge_u32 s56, 4
    s_cbranch_scc1 L_only_30
    s_add_u32 s64, s66, 0x10000
    buffer_store_dwordx4 v[20:23], v11, s[52:55], s64 offen sc1
L_only_30:
    s_waitcnt lgkmcnt(6)
    v_mfma_f32_32x32x16_bf16 v[64:79], v[48:51], v[136:139], v[64:79]
    s_waitcnt vmcnt(8)
    s_waitcnt lgkmcnt(0)
    s_barrier
    v_mfma_f32_32x32x16_bf16 v[80:95], v[52:55], v[136:139], v[80:95]
    ds_read_b64_tr_b16 v[32:33], v6 offset:8192
    ds_read_b64_tr_b16 v[34:35], v6 offset:9216
    ds_read_b64_tr_b16 v[36:37], v7 offset:8192
    ds_read_b64_tr_b16 v[38:39], v7 offset:9216
    ds_read_b64_tr_b16 v[40:41], v8 offset:8192
    ds_read_b64_tr_b16 v[42:43], v8 offset:9216
    ds_read_b64_tr_b16 v[44:45], v9 offset:8192
    ds_read_b64_tr_b16 v[46:47], v9 offset:9216
    v_mfma_f32_32x32x16_bf16 v[64:79], v[56:59], v[140:143], v[64:79]
    ds_read_b64_tr_b16 v[48:49], v6 offset:16384
    ds_read_b64_tr_b16 v[50:51], v6 offset:17408
    s_add_u32 m0, s75, 0x20000
    s_add_u32 s64, s74, 15
    s_and_b32 s64, s64, 31
    s_mul_i32 s64, s64, 0xe000
    buffer_load_dwordx4 v1, s[84:87], s64 offen lds
    v_mfma_f32_32x32x16_bf16 v[80:95], v[60:63], v[140:143], v[80:95]
    ds_read_b64_tr_b16 v[52:53], v7 offset:16384
    ds_read_b64_tr_b16 v[54:55], v7 offset:17408
    s_waitcnt lgkmcnt(10)
    v_mfma_f32_32x32x16_bf16 v[64:79], v[32:35], v[144:147], v[64:79]
    ds_read_b64_tr_b16 v[56:57], v8 offset:16384
    ds_read_b64_tr_b16 v[58:59], v8 offset:17408
    s_add_u32 m0, s75, 0x22000
    s_add_u32 s64, s74, 16
    s_and_b32 s64, s64, 31
    s_mul_i32 s64, s64, 0xe000
    buffer_load_dwordx4 v1, s[84:87], s64 offen lds
    s_waitcnt lgkmcnt(10)
    v_mfma_f32_32x32x16_bf16 v[80:95], v[36:39], v[144:147], v[80:95]
    ds_read_b64_tr_b16 v[60:61], v9 offset:16384
    ds_read_b64_tr_b16 v[62:63], v9 offset:17408
    s_waitcnt lgkmcnt(10)
    v_mfma_f32_32x32x16_bf16 v[96:111], v[40:43], v[144:147], v[96:111]
    ds_read_b64_tr_b16 v[32:33], v6 offset:24576
    ds_read_b64_tr_b16 v[34:35], v6 offset:25600
    s_waitcnt lgkmcnt(10)
    v_mfma_f32_32x32x16_bf16 v[112:127], v[44:47], v[144:147], v[112:127]
    ds_read_b64_tr_b16 v[36:37], v7 offset:24576
    ds_read_b64_tr_b16 v[38:39], v7 offset:25600
    s_waitcnt lgkmcnt(10)
    v_mfma_f32_32x32x16_bf16 v[64:79], v[48:51], v[148:151], v[64:79]
    ds_read_b64_tr_b16 v[40:41], v8 offset:24576
    ds_read_b64_tr_b16 v[42:43], v8 offset:25600
    s_cmp_ge_u32 s56, 4
    s_cbranch_scc1 L_only_31
    s_add_u32 s64, s66, 0x20000
    buffer_store_dwordx4 v[24:27], v11, s[52:55], s64 offen sc1
L_only_31:
    s_add_u32 m0, s75, 0x24000
    s_add_u32 s64, s74, 17
    s_and_b32 s64, s64, 31
    s_mul_i32 s64, s64, 0xe000
    buffer_load_dwordx4 v1, s[84:87], s64 offen lds
    s_waitcnt lgkmcnt(10)
    v_mfma_f32_32x32x16_bf16 v[80:95], v[52:55], v[148:151], v[80:95]
    ds_read_b64_tr_b16 v[44:45], v9 offset:24576
    ds_read_b64_tr_b16 v[46:47], v9 offset:25600
    s_waitcnt lgkmcnt(10)
    v_mfma_f32_32x32x16_bf16 v[96:111], v[56:59], v[148:151], v[96:111]
    ds_read_b64_tr_b16 v[48:49], v6 offset:32768
    ds_read_b64_tr_b16 v[50:51], v6 offset:33792
    s_waitcnt lgkmcnt(10)
    v_mfma_f32_32x32x16_bf16 v[112:127], v[60:63], v[148:151], v[112:127]
    ds_read_b64_tr_b16 v[52:53], v7 offset:32768
    ds_read_b64_tr_b16 v[54:55], v7 offset:33792
    s_waitcnt lgkmcnt(10)
    v_mfma_f32_32x32x16_bf16 v[64:79], v[32:35], v[152:155], v[64:79]
    ds_read_b64_tr_b16 v[56:57], v8 offset:32768
    ds_read_b64_tr_b16 v[58:59], v8 offset:33792
    s_add_u32 m0, s75, 0x26000
    s_add_u32 s64, s74, 18
    s_and_b32 s64, s64, 31
    s_mul_i32 s64, s64, 0xe000
    buffer_load_dwordx4 v1, s[84:87], s64 offen lds
    s_waitcnt lgkmcnt(10)
    v_mfma_f32_32x32x16_bf16 v[80:95], v[36:39], v[152:155], v[80:95]
    ds_read_b64_tr_b16 v[60:61], v9 offset:32768
    ds_read_b64_tr_b16 v[62:63], v9 offset:33792
    s_cmp_ge_u32 s56, 4
    s_cbranch_scc0 L_only_32
    buffer_store_dwordx4 v[20:23], v11, s[52:55], s66 offen offset:512 sc1
L_only_32:
    s_waitcnt lgkmcnt(10)
    v_mfma_f32_32x32x16_bf16 v[96:111], v[40:43], v[152:155], v[96:111]
    s_waitcnt lgkmcnt(8)
    v_mfma_f32_32x32x16_bf16 v[112:127], v[44:47], v[152:155], v[112:127]
    s_waitcnt lgkmcnt(6)
    v_mfma_f32_32x32x16_bf16 v[64:79], v[48:51], v[156:159], v[64:79]
    s_waitcnt vmcnt(6)
    s_waitcnt lgkmcnt(0)
    s_barrier
    v_mfma_f32_32x32x16_bf16 v[80:95], v[52:55], v[156:159], v[80:95]
    ds_read_b64_tr_b16 v[32:33], v6 offset:40960
    ds_read_b64_tr_b16 v[34:35], v6 offset:41984
    ds_read_b64_tr_b16 v[36:37], v7 offset:40960
    ds_read_b64_tr_b16 v[38:39], v7 offset:41984
    ds_read_b64_tr_b16 v[40:41], v8 offset:40960
    ds_read_b64_tr_b16 v[42:43], v8 offset:41984
    ds_read_b64_tr_b16 v[44:45], v9 offset:40960
    ds_read_b64_tr_b16 v[46:47], v9 offset:41984
    v_mfma_f32_32x32x16_bf16 v[96:111], v[56:59], v[156:159], v[96:111]
    ds_read_b64_tr_b16 v[48:49], v6 offset:49152
    ds_read_b64_tr_b16 v[50:51], v6 offset:50176
    s_cmp_ge_u32 s56, 4
    s_cbranch_scc1 L_only_33
    s_add_u32 s64, s66, 0x30000
    buffer_store_dwordx4 v[28:31], v11, s[52:55], s64 offen sc1
L_only_33:
    s_add_u32 m0, s75, 0x16000
    s_add_u32 s64, s74, 19
    s_and_b32 s64, s64, 31
    s_mul_i32 s64, s64, 0xe000
    buffer_load_dwordx4 v1, s[84:87], s64 offen lds
    v_mfma_f32_32x32x16_bf16 v[112:127], v[60:63], v[156:159], v[112:127]
    ds_read_b64_tr_b16 v[52:53], v7 offset:49152
    ds_read_b64_tr_b16 v[54:55], v7 offset:50176
    s_waitcnt lgkmcnt(10)
    v_mfma_f32_32x32x16_bf16 v[64:79], v[32:35], v[160:163], v[64:79]
    ds_read_b64_tr_b16 v[56:57], v8 offset:49152
    ds_read_b64_tr_b16 v[58:59], v8 offset:50176
    s_add_u32 m0, s75, 0x10000
    s_add_u32 s64, s74, 20
    s_and_b32 s64, s64, 31
    s_mul_i32 s64, s64, 0xe000
    buffer_load_dwordx4 v1, s[84:87], s64 offen lds
    s_waitcnt lgkmcnt(10)
    v_mfma_f32_32x32x16_bf16 v[80:95], v[36:39], v[160:163], v[80:95]
    ds_read_b64_tr_b16 v[60:61], v9 offset:49152
    ds_read_b64_tr_b16 v[62:63], v9 offset:50176
    s_waitcnt lgkmcnt(10)
    v_mfma_f32_32x32x16_bf16 v[96:111], v[40:43], v[160:163], v[96:111]
    ds_read_b64_tr_b16 v[32:33], v6 offset:57344
    ds_read_b64_tr_b16 v[34:35], v6 offset:58368
    s_waitcnt lgkmcnt(10)
    v_mfma_f32_32x32x16_bf16 v[112:127], v[44:47], v[160:163], v[112:127]
    ds_read_b64_tr_b16 v[36:37], v7 offset:57344
    ds_read_b64_tr_b16 v[38:39], v7 offset:58368
    s_waitcnt lgkmcnt(10)
    v_mfma_f32_32x32x16_bf16 v[64:79], v[48:51], v[164:167], v[64:79]
    ds_read_b64_tr_b16 v[40:41], v8 offset:57344
    ds_read_b64_tr_b16 v[42:43], v8 offset:58368
    s_add_u32 m0, s75, 0x12000
    s_add_u32 s64, s74, 21
    s_and_b32 s64, s64, 31
    s_mul_i32 s64, s64, 0xe000
    buffer_load_dwordx4 v1, s[84:87], s64 offen lds
    s_waitcnt lgkmcnt(10)
    v_mfma_f32_32x32x16_bf16 v[80:95], v[52:55], v[164:167], v[80:95]
    ds_read_b64_tr_b16 v[44:45], v9 offset:57344
    ds_read_b64_tr_b16 v[46:47], v9 offset:58368
    s_waitcnt lgkmcnt(10)
    v_mfma_f32_32x32x16_bf16 v[96:111], v[56:59], v[164:167], v[96:111]
    v_add_u32 v6, 0x18000, v6
    ds_read_b64_tr_b16 v[48:49], v6 offset:0
    ds_read_b64_tr_b16 v[50:51], v6 offset:1024
    s_waitcnt lgkmcnt(10)
    v_mfma_f32_32x32x16_bf16 v[112:127], v[60:63], v[164:167], v[112:127]
    v_add_u32 v7, 0x18000, v7
    ds_read_b64_tr_b16 v[52:53], v7 offset:0
    ds_read_b64_tr_b16 v[54:55], v7 offset:1024
    s_waitcnt lgkmcnt(10)
    v_mfma_f32_32x32x16_bf16 v[64:79], v[32:35], v[168:171], v[64:79]
    v_add_u32 v8, 0x18000, v8
    ds_read_b64_tr_b16 v[56:57], v8 offset:0
    ds_read_b64_tr_b16 v[58:59], v8 offset:1024
    s_add_u32 m0, s75, 0x14000
    s_add_u32 s64, s74, 22
    s_and_b32 s64, s64, 31
    s_mul_i32 s64, s64, 0xe000
    buffer_load_dwordx4 v1, s[84:87], s64 offen lds
    s_waitcnt lgkmcnt(10)
    v_mfma_f32_32x32x16_bf16 v[80:95], v[36:39], v[168:171], v[80:95]
    v_add_u32 v9, 0x18000, v9
    ds_read_b64_tr_b16 v[60:61], v9 offset:0
    ds_read_b64_tr_b16 v[62:63], v9 offset:1024
    s_waitcnt lgkmcnt(10)
    v_mfma_f32_32x32x16_bf16 v[96:111], v[40:43], v[168:171], v[96:111]
    s_waitcnt lgkmcnt(8)
    v_mfma_f32_32x32x16_bf16 v[112:127], v[44:47], v[168:171], v[112:127]
    s_waitcnt lgkmcnt(6)
    v_mfma_f32_32x32x16_bf16 v[64:79], v[48:51], v[172:175], v[64:79]
    s_waitcnt vmcnt(4)
    s_waitcnt lgkmcnt(0)
    s_barrier
    v_mfma_f32_32x32x16_bf16 v[80:95], v[52:55], v[172:175], v[80:95]
    ds_read_b64_tr_b16 v[32:33], v6 offset:8192
    ds_read_b64_tr_b16 v[34:35], v6 offset:9216
    ds_read_b64_tr_b16 v[36:37], v7 offset:8192
    ds_read_b64_tr_b16 v[38:39], v7 offset:9216
    ds_read_b64_tr_b16 v[40:41], v8 offset:8192
    ds_read_b64_tr_b16 v[42:43], v8 offset:9216
    ds_read_b64_tr_b16 v[44:45], v9 offset:8192
    ds_read_b64_tr_b16 v[46:47], v9 offset:9216
    s_cmp_lg_u32 s56, 0
    s_cbranch_scc1 L_nf_34
    s_lshr_b32 s64, s58, 1
    s_lshl_b32 s64, s64, 5
    s_lshl_b32 s65, s57, 1
    s_add_u32 s64, s64, s65
    s_add_u32 s64, s64, s82
    s_lshl_b32 s64, s64, 7
    s_add_u32 s64, s64, 0x8000
    v_mov_b32 v29, s63
    v_mov_b32 v30, 0
    s_mov_b64 exec, 1
    buffer_store_dword v29, v30, s[52:55], s64 offen sc1
    s_mov_b64 exec, -1
L_nf_34:
    v_mfma_f32_32x32x16_bf16 v[96:111], v[56:59], v[172:175], v[96:111]
    ds_read_b64_tr_b16 v[48:49], v6 offset:16384
    ds_read_b64_tr_b16 v[50:51], v6 offset:17408
    s_add_u32 m0, s75, 0
    s_add_u32 s64, s74, 23
    s_and_b32 s64, s64, 31
    s_mul_i32 s64, s64, 0xe000
    buffer_load_dwordx4 v1, s[84:87], s64 offen lds
    v_mfma_f32_32x32x16_bf16 v[112:127], v[60:63], v[172:175], v[112:127]
    ds_read_b64_tr_b16 v[52:53], v7 offset:16384
    ds_read_b64_tr_b16 v[54:55], v7 offset:17408
    v_and_b32 v29, 1, v0
    v_add_u32 v29, -1, v29
    v_and_b32 v24, s62, v29
    v_and_b32 v25, s62, v29
    v_and_b32 v26, s62, v29
    v_and_b32 v27, s62, v29
    s_waitcnt lgkmcnt(10)
    v_mfma_f32_32x32x16_bf16 v[64:79], v[32:35], v[176:179], v[64:79]
    ds_read_b64_tr_b16 v[56:57], v8 offset:16384
    ds_read_b64_tr_b16 v[58:59], v8 offset:17408
    s_add_u32 m0, s75, 0x2000
    s_add_u32 s64, s74, 24
    s_and_b32 s64, s64, 31
    s_mul_i32 s64, s64, 0xe000
    buffer_load_dwordx4 v1, s[84:87], s64 offen lds
    s_waitcnt lgkmcnt(10)
    v_mfma_f32_32x32x16_bf16 v[80:95], v[36:39], v[176:179], v[80:95]
    ds_read_b64_tr_b16 v[60:61], v9 offset:16384
    ds_read_b64_tr_b16 v[62:63], v9 offset:17408
    s_waitcnt lgkmcnt(10)
    v_mfma_f32_32x32x16_bf16 v[96:111], v[40:43], v[176:179], v[96:111]
    ds_read_b64_tr_b16 v[32:33], v6 offset:24576
    ds_read_b64_tr_b16 v[34:35], v6 offset:25600
    s_waitcnt lgkmcnt(10)
    v_mfma_f32_32x32x16_bf16 v[112:127], v[44:47], v[176:179], v[112:127]
    ds_read_b64_tr_b16 v[36:37], v7 offset:24576
    ds_read_b64_tr_b16 v[38:39], v7 offset:25600
    v_and_b32 v13, 15, v0
    v_lshlrev_b32 v13, 7, v13
    v_and_b32 v23, 31, v0
    v_lshlrev_b32 v20, 2, v23
    s_waitcnt lgkmcnt(10)
    v_mfma_f32_32x32x16_bf16 v[64:79], v[48:51], v[180:183], v[64:79]
    ds_read_b64_tr_b16 v[40:41], v8 offset:24576
    ds_read_b64_tr_b16 v[42:43], v8 offset:25600
    s_add_u32 m0, s75, 0x4000
    s_add_u32 s64, s74, 25
    s_and_b32 s64, s64, 31
    s_mul_i32 s64, s64, 0xe000
    buffer_load_dwordx4 v1, s[84:87], s64 offen lds
    s_waitcnt lgkmcnt(10)
    v_mfma_f32_32x32x16_bf16 v[80:95], v[52:55], v[180:183], v[80:95]
    ds_read_b64_tr_b16 v[44:45], v9 offset:24576
    ds_read_b64_tr_b16 v[46:47], v9 offset:25600
    s_waitcnt lgkmcnt(10)
    v_mfma_f32_32x32x16_bf16 v[96:111], v[56:59], v[180:183], v[96:111]
    ds_read_b64_tr_b16 v[48:49], v6 offset:32768
    ds_read_b64_tr_b16 v[50:51], v6 offset:33792
    s_waitcnt lgkmcnt(10)
    v_mfma_f32_32x32x16_bf16 v[112:127], v[60:63], v[180:183], v[112:127]
    ds_read_b64_tr_b16 v[52:53], v7 offset:32768
    ds_read_b64_tr_b16 v[54:55], v7 offset:33792
    s_lshr_b32 s64, s59, 2
    s_lshl_b32 s64, s64, 12
    s_add_u32 s64, s64, 0x8000
    v_lshl_add_u32 v23, v23, 7, s64
    s_lshl_b32 s65, s11, 9
    s_add_u32 s65, s65, 0x6000
    v_and_b32 v21, 3, v0
    v_lshl_add_u32 v21, v21, 7, s65
    s_waitcnt lgkmcnt(10)
    v_mfma_f32_32x32x16_bf16 v[64:79], v[32:35], v[184:187], v[64:79]
    ds_read_b64_tr_b16 v[56:57], v8 offset:32768
    ds_read_b64_tr_b16 v[58:59], v8 offset:33792
    s_add_u32 m0, s75, 0x6000
    s_add_u32 s64, s74, 26
    s_and_b32 s64, s64, 31
    s_mul_i32 s64, s64, 0xe000
    buffer_load_dwordx4 v1, s[84:87], s64 offen lds
    s_waitcnt lgkmcnt(10)
    v_mfma_f32_32x32x16_bf16 v[80:95], v[36:39], v[184:187], v[80:95]
    ds_read_b64_tr_b16 v[60:61], v9 offset:32768
    ds_read_b64_tr_b16 v[62:63], v9 offset:33792
    s_waitcnt lgkmcnt(10)
    v_mfma_f32_32x32x16_bf16 v[96:111], v[40:43], v[184:187], v[96:111]
    s_waitcnt lgkmcnt(8)
    v_mfma_f32_32x32x16_bf16 v[112:127], v[44:47], v[184:187], v[112:127]
    v_and_b32 v29, 15, v0
    v_lshrrev_b32 v30, 5, v0
    v_lshl_add_u32 v30, v30, 4, v29
    v_lshlrev_b32 v30, 4, v30
    v_min_u32 v29, 1, v29
    v_lshlrev_b32 v29, 4, v29
    v_add_u32 v22, 0x1c100, v29
    v_add_u32 v11, 0x1bd00, v30
    s_waitcnt lgkmcnt(6)
    v_mfma_f32_32x32x16_bf16 v[64:79], v[48:51], v[188:191], v[64:79]
    s_waitcnt vmcnt(7)
    s_waitcnt lgkmcnt(0)
    s_barrier
    v_mfma_f32_32x32x16_bf16 v[80:95], v[52:55], v[188:191], v[80:95]
    ds_read_b64_tr_b16 v[32:33], v6 offset:40960
    ds_read_b64_tr_b16 v[34:35], v6 offset:41984
    ds_read_b64_tr_b16 v[36:37], v7 offset:40960
    ds_read_b64_tr_b16 v[38:39], v7 offset:41984
    ds_read_b64_tr_b16 v[40:41], v8 offset:40960
    ds_read_b64_tr_b16 v[42:43], v8 offset:41984
    ds_read_b64_tr_b16 v[44:45], v9 offset:40960
    ds_read_b64_tr_b16 v[46:47], v9 offset:41984
    v_mfma_f32_32x32x16_bf16 v[96:111], v[56:59], v[188:191], v[96:111]
    ds_read_b64_tr_b16 v[48:49], v6 offset:49152
    ds_read_b64_tr_b16 v[50:51], v6 offset:50176
    s_add_u32 m0, s75, 0x8000
    s_add_u32 s64, s74, 27
    s_and_b32 s64, s64, 31
    s_mul_i32 s64, s64, 0xe000
    buffer_load_dwordx4 v1, s[84:87], s64 offen lds
    v_mfma_f32_32x32x16_bf16 v[112:127], v[60:63], v[188:191], v[112:127]
    ds_read_b64_tr_b16 v[52:53], v7 offset:49152
    ds_read_b64_tr_b16 v[54:55], v7 offset:50176
    v_and_b32 v29, 16, v0
    v_cmp_eq_u32 vcc, 16, v29
    v_add_u32 v15, 0x200, v11
    v_add_u32 v4, 0x1bd00, v10
    v_cndmask_b32 v11, v11, v22, vcc
    v_cndmask_b32 v22, v15, v22, vcc
    v_mov_b32 v14, 0xdddd
    s_waitcnt lgkmcnt(10)
    v_mfma_f32_32x32x16_bf16 v[64:79], v[32:35], v[192:195], v[64:79]
    ds_read_b64_tr_b16 v[56:57], v8 offset:49152
    ds_read_b64_tr_b16 v[58:59], v8 offset:50176
    s_add_u32 m0, s75, 0xa000
    s_add_u32 s64, s74, 28
    s_and_b32 s64, s64, 31
    s_mul_i32 s64, s64, 0xe000
    buffer_load_dwordx4 v1, s[84:87], s64 offen lds
    s_waitcnt lgkmcnt(10)
    v_mfma_f32_32x32x16_bf16 v[80:95], v[36:39], v[192:195], v[80:95]
    ds_read_b64_tr_b16 v[60:61], v9 offset:49152
    ds_read_b64_tr_b16 v[62:63], v9 offset:50176
    s_waitcnt lgkmcnt(10)
    v_mfma_f32_32x32x16_bf16 v[96:111], v[40:43], v[192:195], v[96:111]
    ds_read_b64_tr_b16 v[32:33], v6 offset:57344
    ds_read_b64_tr_b16 v[34:35], v6 offset:58368
    s_waitcnt lgkmcnt(10)
    v_mfma_f32_32x32x16_bf16 v[112:127], v[44:47], v[192:195], v[112:127]
    ds_read_b64_tr_b16 v[36:37], v7 offset:57344
    ds_read_b64_tr_b16 v[38:39], v7 offset:58368
    v_lshrrev_b32 v29, 3, v0
    v_bfe_u32 v30, v0, 4, 1
    v_lshlrev_b32 v30, 2, v30
    v_and_b32 v15, 7, v0
    v_xor_b32 v30, v30, v15
    v_lshlrev_b32 v30, 4, v30
    v_lshl_add_u32 v12, v29, 10, v30
    s_waitcnt lgkmcnt(10)
    v_mfma_f32_32x32x16_bf16 v[64:79], v[48:51], v[196:199], v[64:79]
    ds_read_b64_tr_b16 v[40:41], v8 offset:57344
    ds_read_b64_tr_b16 v[42:43], v8 offset:58368
    s_add_u32 m0, s75, 0xc000
    s_add_u32 s64, s74, 29
    s_and_b32 s64, s64, 31
    s_mul_i32 s64, s64, 0xe000
    buffer_load_dwordx4 v1, s[84:87], s64 offen lds
    s_waitcnt lgkmcnt(10)
    v_mfma_f32_32x32x16_bf16 v[80:95], v[52:55], v[196:199], v[80:95]
    ds_read_b64_tr_b16 v[44:45], v9 offset:57344
    ds_read_b64_tr_b16 v[46:47], v9 offset:58368
    s_waitcnt lgkmcnt(10)
    v_mfma_f32_32x32x16_bf16 v[96:111], v[56:59], v[196:199], v[96:111]
    v_add_u32 v6, 0xffffe000, v6
    ds_read_b64_tr_b16 v[48:49], v6 offset:0
    ds_read_b64_tr_b16 v[50:51], v6 offset:1024
    s_waitcnt lgkmcnt(10)
    v_mfma_f32_32x32x16_bf16 v[112:127], v[60:63], v[196:199], v[112:127]
    v_add_u32 v7, 0xffffe000, v7
    ds_read_b64_tr_b16 v[52:53], v7 offset:0
    ds_read_b64_tr_b16 v[54:55], v7 offset:1024
    s_lshr_b32 s64, s56, 1
    s_mul_i32 s64, s64, 0x70000
    s_and_b32 s65, s56, 1
    s_lshl_b32 s65, s65, 13
    s_add_u32 s64, s64, s65
    s_lshl_b32 s65, s60, 7
    s_add_u32 s64, s64, s65
    v_add_u32 v12, s64, v12
    s_waitcnt lgkmcnt(10)
    v_mfma_f32_32x32x16_bf16 v[64:79], v[32:35], v[200:203], v[64:79]
    v_add_u32 v8, 0xffffe000, v8
    ds_read_b64_tr_b16 v[56:57], v8 offset:0
    ds_read_b64_tr_b16 v[58:59], v8 offset:1024
    s_add_u32 m0, s75, 0xe000
    s_add_u32 s64, s74, 30
    s_and_b32 s64, s64, 31
    s_mul_i32 s64, s64, 0xe000
    buffer_load_dwordx4 v1, s[84:87], s64 offen lds
    s_waitcnt lgkmcnt(10)
    v_mfma_f32_32x32x16_bf16 v[80:95], v[36:39], v[200:203], v[80:95]
    v_add_u32 v9, 0xffffe000, v9
    ds_read_b64_tr_b16 v[60:61], v9 offset:0
    ds_read_b64_tr_b16 v[62:63], v9 offset:1024
    s_waitcnt lgkmcnt(10)
    v_mfma_f32_32x32x16_bf16 v[96:111], v[40:43], v[200:203], v[96:111]
    s_waitcnt lgkmcnt(8)
    v_mfma_f32_32x32x16_bf16 v[112:127], v[44:47], v[200:203], v[112:127]
    s_waitcnt lgkmcnt(6)
    v_mfma_f32_32x32x16_bf16 v[64:79], v[48:51], v[204:207], v[64:79]
    s_waitcnt vmcnt(7)
    s_waitcnt lgkmcnt(0)
    s_barrier
    v_mfma_f32_32x32x16_bf16 v[80:95], v[52:55], v[204:207], v[80:95]
    v_add_u32 v6, 0xffffa000, v6
    ds_read_b64_tr_b16 v[32:33], v6 offset:0
    ds_read_b64_tr_b16 v[34:35], v6 offset:1024
    v_add_u32 v7, 0xffffa000, v7
    ds_read_b64_tr_b16 v[36:37], v7 offset:0
    ds_read_b64_tr_b16 v[38:39], v7 offset:1024
    v_add_u32 v8, 0xffffa000, v8
    ds_read_b64_tr_b16 v[40:41], v8 offset:0
    ds_read_b64_tr_b16 v[42:43], v8 offset:1024
    v_add_u32 v9, 0xffffa000, v9
    ds_read_b64_tr_b16 v[44:45], v9 offset:0
    ds_read_b64_tr_b16 v[46:47], v9 offset:1024
    v_mfma_f32_32x32x16_bf16 v[96:111], v[56:59], v[204:207], v[96:111]
    ds_read_b64_tr_b16 v[48:49], v6 offset:8192
    ds_read_b64_tr_b16 v[50:51], v6 offset:9216
    v_mfma_f32_32x32x16_bf16 v[112:127], v[60:63], v[204:207], v[112:127]
    ds_read_b64_tr_b16 v[52:53], v7 offset:8192
    ds_read_b64_tr_b16 v[54:55], v7 offset:9216
    s_add_u32 s64, s76, 0x1e100
    v_lshrrev_b32 v31, 1, v0
    v_mul_u32_u24 v31, 0x4100, v31
    v_and_b32 v29, 1, v0
    v_lshl_add_u32 v31, v29, 4, v31
    v_add_u32 v31, s64, v31
    s_mov_b64 exec, 63
    ds_write_b128 v31, v[24:27]
    s_mov_b64 exec, -1
    s_waitcnt lgkmcnt(11)
    v_mfma_f32_32x32x16_bf16 v[64:79], v[32:35], v[208:211], v[64:79]
    ds_read_b64_tr_b16 v[56:57], v8 offset:8192
    ds_read_b64_tr_b16 v[58:59], v8 offset:9216
    s_add_u32 m0, s75, 0x18000
    s_add_u32 s64, s74, 31
    s_and_b32 s64, s64, 31
    s_mul_i32 s64, s64, 0xe000
    buffer_load_dwordx4 v1, s[84:87], s64 offen lds
    s_waitcnt lgkmcnt(11)
    v_mfma_f32_32x32x16_bf16 v[80:95], v[36:39], v[208:211], v[80:95]
    ds_read_b64_tr_b16 v[60:61], v9 offset:8192
    ds_read_b64_tr_b16 v[62:63], v9 offset:9216
    s_waitcnt lgkmcnt(11)
    v_mfma_f32_32x32x16_bf16 v[96:111], v[40:43], v[208:211], v[96:111]
    ds_read_b64_tr_b16 v[32:33], v6 offset:16384
    ds_read_b64_tr_b16 v[34:35], v6 offset:17408
    s_waitcnt lgkmcnt(11)
    v_mfma_f32_32x32x16_bf16 v[112:127], v[44:47], v[208:211], v[112:127]
    ds_read_b64_tr_b16 v[36:37], v7 offset:16384
    ds_read_b64_tr_b16 v[38:39], v7 offset:17408
    v_mov_b32 v176, 0
    v_mov_b32 v177, 0
    v_mov_b32 v178, 0
    v_mov_b32 v179, 0
    v_mov_b32 v181, 0
    v_mov_b32 v182, 0
    v_mov_b32 v183, 0
    v_mov_b32 v184, 0
    v_mov_b32 v185, 0
    v_mov_b32 v186, 0
    v_mov_b32 v187, 0
    v_and_b32 v180, 0x3f80, v5
    s_waitcnt lgkmcnt(11)
    v_mfma_f32_32x32x16_bf16 v[64:79], v[48:51], v[212:215], v[64:79]
    ds_read_b64_tr_b16 v[40:41], v8 offset:16384
    ds_read_b64_tr_b16 v[42:43], v8 offset:17408
    s_waitcnt lgkmcnt(11)
    v_mfma_f32_32x32x16_bf16 v[80:95], v[52:55], v[212:215], v[80:95]
    ds_read_b64_tr_b16 v[44:45], v9 offset:16384
    ds_read_b64_tr_b16 v[46:47], v9 offset:17408
    s_waitcnt lgkmcnt(10)
    v_mfma_f32_32x32x16_bf16 v[96:111], v[56:59], v[212:215], v[96:111]
    v_add_u32 v6, 0xffff0000, v6
    ds_read_b64_tr_b16 v[48:49], v6 offset:0
    ds_read_b64_tr_b16 v[50:51], v6 offset:1024
    s_cmp_eq_u32 s56, 2
    s_cbranch_scc0 L_when_35
    s_mov_b32 s68, 0
    buffer_load_dword v28, v21, s[52:55], s68 offen sc1
L_when_35:
    s_cmp_eq_u32 s56, 1
    s_cbranch_scc0 L_when_36
    s_mov_b32 s68, 0
    s_waitcnt vmcnt(0)
    buffer_load_dword v28, v23, s[52:55], s68 offen sc1
L_when_36:
    s_waitcnt lgkmcnt(10)
    v_mfma_f32_32x32x16_bf16 v[112:127], v[60:63], v[212:215], v[112:127]
    v_add_u32 v7, 0xffff0000, v7
    ds_read_b64_tr_b16 v[52:53], v7 offset:0
    ds_read_b64_tr_b16 v[54:55], v7 offset:1024
    v_mov_b32 v188, -1
    v_mov_b32 v189, -1
    v_mov_b32 v190, -1
    v_mov_b32 v191, -1
    v_mov_b32 v192, v5
    s_add_u32 s64, s76, 0x2400
    v_lshrrev_b32 v15, 1, v0
    v_mul_u32_u24 v15, 0x4100, v15
    v_and_b32 v29, 1, v0
    v_lshl_add_u32 v15, v29, 4, v15
    v_add_u32 v193, s64, v15
    s_waitcnt lgkmcnt(10)
    v_mfma_f32_32x32x16_bf16 v[64:79], v[32:35], v[216:219], v[64:79]
    v_add_u32 v8, 0xffff0000, v8
    ds_read_b64_tr_b16 v[56:57], v8 offset:0
    ds_read_b64_tr_b16 v[58:59], v8 offset:1024
    s_waitcnt lgkmcnt(10)
    v_mfma_f32_32x32x16_bf16 v[80:95], v[36:39], v[216:219], v[80:95]
    v_add_u32 v9, 0xffff0000, v9
    ds_read_b64_tr_b16 v[60:61], v9 offset:0
    ds_read_b64_tr_b16 v[62:63], v9 offset:1024
    s_waitcnt lgkmcnt(10)
    v_mfma_f32_32x32x16_bf16 v[96:111], v[40:43], v[216:219], v[96:111]
    s_waitcnt lgkmcnt(8)
    v_mfma_f32_32x32x16_bf16 v[112:127], v[44:47], v[216:219], v[112:127]
    s_waitcnt lgkmcnt(6)
    v_mfma_f32_32x32x16_bf16 v[64:79], v[48:51], v[220:223], v[64:79]
    s_cmp_eq_u32 s56, 2
    s_cbranch_scc0 L_when_37
    s_waitcnt vmcnt(0)
    v_cmp_ne_u32 vcc, s63, v28
    s_cbranch_vccz L_ok_38
    s_mov_b32 s79, 0x40000
L_poll_39:
    buffer_load_dword v28, v21, s[52:55], s68 offen sc1
    s_waitcnt vmcnt(0)
    v_cmp_ne_u32 vcc, s63, v28
    s_cbranch_vccz L_ok_38
    s_sub_u32 s79, s79, 1
    s_cmp_lg_u32 s79, 0
    s_cbranch_scc1 L_poll_39
L_ok_38:
L_when_37:
    s_cmp_eq_u32 s56, 1
    s_cbranch_scc0 L_when_40
    s_waitcnt vmcnt(0)
    v_cmp_ne_u32 vcc, s63, v28
    s_cbranch_vccz L_ok_41
    s_mov_b32 s79, 0x40000
L_poll_42:
    buffer_load_dword v28, v23, s[52:55], s68 offen sc1
    s_waitcnt vmcnt(0)
    v_cmp_ne_u32 vcc, s63, v28
    s_cbranch_vccz L_ok_41
    s_sub_u32 s79, s79, 1
    s_cmp_lg_u32 s79, 0
    s_cbranch_scc1 L_poll_42
L_ok_41:
L_when_40:
    s_waitcnt vmcnt(0)
    s_waitcnt lgkmcnt(0)
    s_barrier
    v_mfma_f32_32x32x16_bf16 v[80:95], v[52:55], v[220:223], v[80:95]
    ds_read_b64_tr_b16 v[32:33], v6 offset:8192
    ds_read_b64_tr_b16 v[34:35], v6 offset:9216
    ds_read_b64_tr_b16 v[36:37], v6 offset:16384
    ds_read_b64_tr_b16 v[38:39], v6 offset:17408
    ds_read_b64_tr_b16 v[40:41], v6 offset:24576
    ds_read_b64_tr_b16 v[42:43], v6 offset:25600
    ds_read_b64_tr_b16 v[44:45], v6 offset:32768
    ds_read_b64_tr_b16 v[46:47], v6 offset:33792
    s_setprio 1
    v_mfma_f32_32x32x16_bf16 v[96:111], v[56:59], v[220:223], v[96:111]
    ds_read_b64_tr_b16 v[48:49], v6 offset:40960
    ds_read_b64_tr_b16 v[50:51], v6 offset:41984
    s_lshl_b32 s64, s11, 3
    s_and_b32 s65, s56, 4
    s_add_u32 s64, s64, s65
    s_lshl_b32 s64, s64, 7
    s_add_u32 s64, s64, 0x1000
    buffer_load_dword v132, v20, s[52:55], s64 offen offset:0 sc1
    buffer_load_dword v133, v20, s[52:55], s64 offen offset:128 sc1
    buffer_load_dword v134, v20, s[52:55], s64 offen offset:256 sc1
    buffer_load_dword v135, v20, s[52:55], s64 offen offset:384 sc1
    v_mfma_f32_32x32x16_bf16 v[112:127], v[60:63], v[220:223], v[112:127]
    ds_read_b64_tr_b16 v[52:53], v6 offset:49152
    ds_read_b64_tr_b16 v[54:55], v6 offset:50176
    s_add_u32 s64, s76, 0x12800
    v_lshrrev_b32 v31, 1, v0
    v_mul_u32_u24 v31, 0x4100, v31
    v_and_b32 v29, 1, v0
    v_lshl_add_u32 v31, v29, 4, v31
    v_add_u32 v31, s64, v31
    s_mov_b64 exec, 3
    ds_write_b128 v31, v[24:27]
    s_mov_b64 exec, -1
    s_waitcnt lgkmcnt(11)
    v_mfma_f32_32x32x16_bf16 v[64:79], v[32:35], v[224:227], v[64:79]
    ds_read_b64_tr_b16 v[56:57], v6 offset:57344
    ds_read_b64_tr_b16 v[58:59], v6 offset:58368
    s_add_u32 m0, s75, 0x1bd00
    s_add_u32 s64, s60, 0
    s_and_b32 s64, s64, 7
    s_lshl_b32 s64, s64, 13
    s_add_u32 s64, s64, s77
    s_add_u32 s64, s64, 0x260000
    buffer_load_dwordx4 v10, s[52:55], s64 offen sc1 lds
    s_mul_i32 s64, s67, 0x70
    s_lshl_b32 s65, s11, 3
    s_add_u32 s64, s64, s65
    s_and_b32 s65, s56, 4
    s_add_u32 s64, s64, s65
    s_lshl_b32 s64, s64, 10
    s_add_u32 s66, s64, 0x860000
    s_waitcnt lgkmcnt(11)
    v_mfma_f32_32x32x16_bf16 v[64:79], v[36:39], v[228:231], v[64:79]
    v_add_u32 v6, 0x18000, v6
    ds_read_b64_tr_b16 v[60:61], v6 offset:0
    ds_read_b64_tr_b16 v[62:63], v6 offset:1024
    s_waitcnt lgkmcnt(11)
    v_mfma_f32_32x32x16_bf16 v[64:79], v[40:43], v[232:235], v[64:79]
    ds_read_b64_tr_b16 v[32:33], v7 offset:8192
    ds_read_b64_tr_b16 v[34:35], v7 offset:9216
    s_add_u32 m0, s76, 0x1dd00
    s_add_u32 s64, s60, 0
    s_and_b32 s64, s64, 7
    s_lshl_b32 s64, s64, 13
    s_add_u32 s64, s64, s77
    s_add_u32 s64, s64, 0x460000
    buffer_load_dwordx4 v10, s[52:55], s64 offen sc1 lds
    s_waitcnt lgkmcnt(11)
    v_mfma_f32_32x32x16_bf16 v[64:79], v[44:47], v[236:239], v[64:79]
    ds_read_b64_tr_b16 v[36:37], v7 offset:16384
    ds_read_b64_tr_b16 v[38:39], v7 offset:17408
    s_waitcnt lgkmcnt(11)
    v_mfma_f32_32x32x16_bf16 v[64:79], v[48:51], v[240:243], v[64:79]
    ds_read_b64_tr_b16 v[40:41], v7 offset:24576
    ds_read_b64_tr_b16 v[42:43], v7 offset:25600
    s_lshl_b32 s64, s60, 13
    s_add_u32 s64, s64, s77
    s_add_u32 s64, s64, 0x60000
    buffer_load_dwordx4 v[128:131], v10, s[52:55], s64 offen sc1
    s_waitcnt lgkmcnt(11)
    v_mfma_f32_32x32x16_bf16 v[64:79], v[52:55], v[244:247], v[64:79]
    ds_read_b64_tr_b16 v[44:45], v7 offset:32768
    ds_read_b64_tr_b16 v[46:47], v7 offset:33792
    s_waitcnt vmcnt(6)
    v_and_b32 v29, s61, v132
    v_sub_f32 v30, v132, v29
    v_cvt_pk_bf16_f32 v136, v29, v29
    v_cvt_pk_bf16_f32 v137, v30, 0
    v_and_b32 v136, v5, v136
    v_and_b32 v137, v5, v137
    v_mov_b32 v138, 0
    v_mov_b32 v139, 0
    s_waitcnt lgkmcnt(10)
    v_mfma_f32_32x32x16_bf16 v[64:79], v[56:59], v[248:251], v[64:79]
    ds_read_b64_tr_b16 v[48:49], v7 offset:40960
    ds_read_b64_tr_b16 v[50:51], v7 offset:41984
    s_add_u32 m0, s75, 0x1fe00
    s_add_u32 s64, s60, 1
    s_and_b32 s64, s64, 7
    s_lshl_b32 s64, s64, 13
    s_add_u32 s64, s64, s77
    s_add_u32 s64, s64, 0x260000
    buffer_load_dwordx4 v10, s[52:55], s64 offen sc1 lds
    s_waitcnt lgkmcnt(10)
    v_mfma_f32_32x32x16_bf16 v[64:79], v[60:63], v[252:255], v[64:79]
    ds_read_b64_tr_b16 v[52:53], v7 offset:49152
    ds_read_b64_tr_b16 v[54:55], v7 offset:50176
    v_mfma_f32_32x32x16_bf16 v[64:79], v[136:139], v[16:19], v[64:79]
    s_waitcnt lgkmcnt(10)
    v_mfma_f32_32x32x16_bf16 v[80:95], v[32:35], v[224:227], v[80:95]
    ds_read_b64_tr_b16 v[56:57], v7 offset:57344
    ds_read_b64_tr_b16 v[58:59], v7 offset:58368
    s_add_u32 m0, s76, 0x21e00
    s_add_u32 s64, s60, 1
    s_and_b32 s64, s64, 7
    s_lshl_b32 s64, s64, 13
    s_add_u32 s64, s64, s77
    s_add_u32 s64, s64, 0x460000
    buffer_load_dwordx4 v10, s[52:55], s64 offen sc1 lds
    s_waitcnt lgkmcnt(10)
    v_mfma_f32_32x32x16_bf16 v[80:95], v[36:39], v[228:231], v[80:95]
    v_add_u32 v7, 0x18000, v7
    ds_read_b64_tr_b16 v[60:61], v7 offset:0
    ds_read_b64_tr_b16 v[62:63], v7 offset:1024
    v_mul_f32 v168, v3, v64
    v_mul_f32 v169, v3, v65
    v_mul_f32 v170, v3, v66
    v_mul_f32 v171, v3, v67
    v_mul_f32 v172, v3, v68
    v_mul_f32 v173, v3, v69
    s_waitcnt lgkmcnt(10)
    v_mfma_f32_32x32x16_bf16 v[80:95], v[40:43], v[232:235], v[80:95]
    ds_read_b64_tr_b16 v[32:33], v8 offset:8192
    ds_read_b64_tr_b16 v[34:35], v8 offset:9216
    s_add_u32 m0, s75, 0x23f00
    s_add_u32 s64, s60, 2
    s_and_b32 s64, s64, 7
    s_lshl_b32 s64, s64, 13
    s_add_u32 s64, s64, s77
    s_add_u32 s64, s64, 0x260000
    buffer_load_dwordx4 v10, s[52:55], s64 offen sc1 lds
    v_mul_f32 v174, v3, v70
    v_mul_f32 v175, v3, v71
    v_exp_f32 v168, v168
    v_exp_f32 v169, v169
    v_exp_f32 v170, v170
    v_exp_f32 v171, v171
    s_waitcnt lgkmcnt(10)
    v_mfma_f32_32x32x16_bf16 v[80:95], v[44:47], v[236:239], v[80:95]
    ds_read_b64_tr_b16 v[36:37], v8 offset:16384
    ds_read_b64_tr_b16 v[38:39], v8 offset:17408
    v_exp_f32 v172, v172
    v_exp_f32 v173, v173
    v_exp_f32 v174, v174
    v_exp_f32 v175, v175
    v_mul_f32 v72, v64, v72
    v_mul_f32 v73, v65, v73
    s_waitcnt lgkmcnt(10)
    v_mfma_f32_32x32x16_bf16 v[80:95], v[48:51], v[240:243], v[80:95]
    ds_read_b64_tr_b16 v[40:41], v8 offset:24576
    ds_read_b64_tr_b16 v[42:43], v8 offset:25600
    s_add_u32 m0, s76, 0x25f00
    s_add_u32 s64, s60, 2
    s_and_b32 s64, s64, 7
    s_lshl_b32 s64, s64, 13
    s_add_u32 s64, s64, s77
    s_add_u32 s64, s64, 0x460000
    buffer_load_dwordx4 v10, s[52:55], s64 offen sc1 lds
    v_mul_f32 v74, v66, v74
    v_mul_f32 v75, v67, v75
    v_mul_f32 v76, v68, v76
    v_mul_f32 v77, v69, v77
    v_mul_f32 v78, v70, v78
    v_mul_f32 v79, v71, v79
    s_waitcnt lgkmcnt(10)
    v_mfma_f32_32x32x16_bf16 v[80:95], v[52:55], v[244:247], v[80:95]
    ds_read_b64_tr_b16 v[44:45], v8 offset:32768
    ds_read_b64_tr_b16 v[46:47], v8 offset:33792
    s_waitcnt vmcnt(9)
    v_and_b32 v29, s61, v133
    v_sub_f32 v30, v133, v29
    v_cvt_pk_bf16_f32 v140, v29, v29
    v_cvt_pk_bf16_f32 v141, v30, 0
    v_and_b32 v140, v5, v140
    v_and_b32 v141, v5, v141
    v_mov_b32 v142, 0
    v_mov_b32 v143, 0
    v_fma_f32 v168, v168, v2, v2
    v_fma_f32 v169, v169, v2, v2
    v_fma_f32 v170, v170, v2, v2
    v_fma_f32 v171, v171, v2, v2
    v_fma_f32 v172, v172, v2, v2
    v_fma_f32 v173, v173, v2, v2
    s_waitcnt lgkmcnt(10)
    v_mfma_f32_32x32x16_bf16 v[80:95], v[56:59], v[248:251], v[80:95]
    ds_read_b64_tr_b16 v[48:49], v8 offset:40960
    ds_read_b64_tr_b16 v[50:51], v8 offset:41984
    v_fma_f32 v174, v174, v2, v2
    v_fma_f32 v175, v175, v2, v2
    v_rcp_f32 v168, v168
    v_rcp_f32 v169, v169
    v_rcp_f32 v170, v170
    v_rcp_f32 v171, v171
    s_waitcnt lgkmcnt(10)
    v_mfma_f32_32x32x16_bf16 v[80:95], v[60:63], v[252:255], v[80:95]
    ds_read_b64_tr_b16 v[52:53], v8 offset:49152
    ds_read_b64_tr_b16 v[54:55], v8 offset:50176
    v_rcp_f32 v172, v172
    v_rcp_f32 v173, v173
    v_rcp_f32 v174, v174
    v_rcp_f32 v175, v175
    v_mul_f32 v72, v72, v168
    v_mul_f32 v73, v73, v169
    v_mfma_f32_32x32x16_bf16 v[80:95], v[140:143], v[16:19], v[80:95]
    s_waitcnt lgkmcnt(10)
    v_mfma_f32_32x32x16_bf16 v[96:111], v[32:35], v[224:227], v[96:111]
    ds_read_b64_tr_b16 v[56:57], v8 offset:57344
    ds_read_b64_tr_b16 v[58:59], v8 offset:58368
    s_add_u32 m0, s75, 0x10400
    s_add_u32 s64, s60, 3
    s_and_b32 s64, s64, 7
    s_lshl_b32 s64, s64, 13
    s_add_u32 s64, s64, s77
    s_add_u32 s64, s64, 0x260000
    buffer_load_dwordx4 v10, s[52:55], s64 offen sc1 lds
    s_waitcnt lgkmcnt(10)
    v_mfma_f32_32x32x16_bf16 v[96:111], v[36:39], v[228:231], v[96:111]
    v_add_u32 v8, 0x18000, v8
    ds_read_b64_tr_b16 v[60:61], v8 offset:0
    ds_read_b64_tr_b16 v[62:63], v8 offset:1024
    v_mul_f32 v74, v74, v170
    v_mul_f32 v75, v75, v171
    v_mul_f32 v76, v76, v172
    v_mul_f32 v77, v77, v173
    v_mul_f32 v78, v78, v174
    v_mul_f32 v79, v79, v175
    s_waitcnt lgkmcnt(10)
    v_mfma_f32_32x32x16_bf16 v[96:111], v[40:43], v[232:235], v[96:111]
    ds_read_b64_tr_b16 v[32:33], v9 offset:8192
    ds_read_b64_tr_b16 v[34:35], v9 offset:9216
    v_cvt_pk_bf16_f32 v152, v72, v73
    v_cvt_pk_bf16_f32 v153, v74, v75
    v_cvt_pk_bf16_f32 v154, v76, v77
    v_cvt_pk_bf16_f32 v155, v78, v79
    buffer_store_dwordx4 v[152:155], v10, s[52:55], s66 offen offset:0 sc1
    v_mul_f32 v168, v3, v80
    s_waitcnt lgkmcnt(10)
    v_mfma_f32_32x32x16_bf16 v[96:111], v[44:47], v[236:239], v[96:111]
    ds_read_b64_tr_b16 v[36:37], v9 offset:16384
    ds_read_b64_tr_b16 v[38:39], v9 offset:17408
    v_mul_f32 v169, v3, v81
    v_mul_f32 v170, v3, v82
    v_mul_f32 v171, v3, v83
    v_mul_f32 v172, v3, v84
    v_mul_f32 v173, v3, v85
    v_mul_f32 v174, v3, v86
    s_waitcnt lgkmcnt(10)
    v_mfma_f32_32x32x16_bf16 v[96:111], v[48:51], v[240:243], v[96:111]
    ds_read_b64_tr_b16 v[40:41], v9 offset:24576
    ds_read_b64_tr_b16 v[42:43], v9 offset:25600
    s_add_u32 m0, s76, 0x12400
    s_add_u32 s64, s60, 3
    s_and_b32 s64, s64, 7
    s_lshl_b32 s64, s64, 13
    s_add_u32 s64, s64, s77
    s_add_u32 s64, s64, 0x460000
    buffer_load_dwordx4 v10, s[52:55], s64 offen sc1 lds
    v_mul_f32 v175, v3, v87
    v_exp_f32 v168, v168
    v_exp_f32 v169, v169
    v_exp_f32 v170, v170
    v_exp_f32 v171, v171
    v_exp_f32 v172, v172
    s_waitcnt lgkmcnt(10)
    v_mfma_f32_32x32x16_bf16 v[96:111], v[52:55], v[244:247], v[96:111]
    ds_read_b64_tr_b16 v[44:45], v9 offset:32768
    ds_read_b64_tr_b16 v[46:47], v9 offset:33792
    s_waitcnt vmcnt(11)
    v_and_b32 v29, s61, v134
    v_sub_f32 v30, v134, v29
    v_cvt_pk_bf16_f32 v144, v29, v29
    v_cvt_pk_bf16_f32 v145, v30, 0
    v_and_b32 v144, v5, v144
    v_and_b32 v145, v5, v145
    v_mov_b32 v146, 0
    v_mov_b32 v147, 0
    v_exp_f32 v173, v173
    v_exp_f32 v174, v174
    v_exp_f32 v175, v175
    v_mul_f32 v88, v80, v88
    v_mul_f32 v89, v81, v89
    v_mul_f32 v90, v82, v90
    s_waitcnt lgkmcnt(10)
    v_mfma_f32_32x32x16_bf16 v[96:111], v[56:59], v[248:251], v[96:111]
    ds_read_b64_tr_b16 v[48:49], v9 offset:40960
    ds_read_b64_tr_b16 v[50:51], v9 offset:41984
    v_mul_f32 v91, v83, v91
    v_mul_f32 v92, v84, v92
    v_mul_f32 v93, v85, v93
    v_mul_f32 v94, v86, v94
    v_mul_f32 v95, v87, v95
    v_fma_f32 v168, v168, v2, v2
    s_waitcnt lgkmcnt(10)
    v_mfma_f32_32x32x16_bf16 v[96:111], v[60:63], v[252:255], v[96:111]
    ds_read_b64_tr_b16 v[52:53], v9 offset:49152
    ds_read_b64_tr_b16 v[54:55], v9 offset:50176
    v_fma_f32 v169, v169, v2, v2
    v_fma_f32 v170, v170, v2, v2
    v_fma_f32 v171, v171, v2, v2
    v_fma_f32 v172, v172, v2, v2
    v_fma_f32 v173, v173, v2, v2
    v_fma_f32 v174, v174, v2, v2
    v_mfma_f32_32x32x16_bf16 v[96:111], v[144:147], v[16:19], v[96:111]
    s_waitcnt lgkmcnt(10)
    v_mfma_f32_32x32x16_bf16 v[112:127], v[32:35], v[224:227], v[112:127]
    ds_read_b64_tr_b16 v[56:57], v9 offset:57344
    ds_read_b64_tr_b16 v[58:59], v9 offset:58368
    s_waitcnt lgkmcnt(10)
    v_mfma_f32_32x32x16_bf16 v[112:127], v[36:39], v[228:231], v[112:127]
    v_add_u32 v9, 0x18000, v9
    ds_read_b64_tr_b16 v[60:61], v9 offset:0
    ds_read_b64_tr_b16 v[62:63], v9 offset:1024
    v_fma_f32 v175, v175, v2, v2
    v_rcp_f32 v168, v168
    v_rcp_f32 v169, v169
    v_rcp_f32 v170, v170
    v_rcp_f32 v171, v171
    v_rcp_f32 v172, v172
    s_waitcnt lgkmcnt(10)
    v_mfma_f32_32x32x16_bf16 v[112:127], v[40:43], v[232:235], v[112:127]
    v_rcp_f32 v173, v173
    v_rcp_f32 v174, v174
    v_rcp_f32 v175, v175
    v_mul_f32 v88, v88, v168
    v_mul_f32 v89, v89, v169
    v_mul_f32 v90, v90, v170
    s_waitcnt lgkmcnt(8)
    v_mfma_f32_32x32x16_bf16 v[112:127], v[44:47], v[236:239], v[112:127]
    v_mul_f32 v91, v91, v171
    v_mul_f32 v92, v92, v172
    v_mul_f32 v93, v93, v173
    v_mul_f32 v94, v94, v174
    v_mul_f32 v95, v95, v175
    v_cvt_pk_bf16_f32 v156, v88, v89
    s_waitcnt lgkmcnt(6)
    v_mfma_f32_32x32x16_bf16 v[112:127], v[48:51], v[240:243], v[112:127]
    v_cvt_pk_bf16_f32 v157, v90, v91
    v_cvt_pk_bf16_f32 v158, v92, v93
    v_cvt_pk_bf16_f32 v159, v94, v95
    buffer_store_dwordx4 v[156:159], v10, s[52:55], s66 offen offset:1024 sc1
    v_mul_f32 v168, v3, v96
    v_mul_f32 v169, v3, v97
    s_waitcnt lgkmcnt(4)
    v_mfma_f32_32x32x16_bf16 v[112:127], v[52:55], v[244:247], v[112:127]
    s_waitcnt vmcnt(11)
    v_and_b32 v29, s61, v135
    v_sub_f32 v30, v135, v29
    v_cvt_pk_bf16_f32 v148, v29, v29
    v_cvt_pk_bf16_f32 v149, v30, 0
    v_and_b32 v148, v5, v148
    v_and_b32 v149, v5, v149
    v_mov_b32 v150, 0
    v_mov_b32 v151, 0
    v_mul_f32 v170, v3, v98
    v_mul_f32 v171, v3, v99
    v_mul_f32 v172, v3, v100
    v_mul_f32 v173, v3, v101
    v_mul_f32 v174, v3, v102
    v_mul_f32 v175, v3, v103
    s_waitcnt lgkmcnt(2)
    v_mfma_f32_32x32x16_bf16 v[112:127], v[56:59], v[248:251], v[112:127]
    v_exp_f32 v168, v168
    v_exp_f32 v169, v169
    v_exp_f32 v170, v170
    v_exp_f32 v171, v171
    v_exp_f32 v172, v172
    v_exp_f32 v173, v173
    s_waitcnt lgkmcnt(0)
    v_mfma_f32_32x32x16_bf16 v[112:127], v[60:63], v[252:255], v[112:127]
    v_exp_f32 v174, v174
    v_exp_f32 v175, v175
    v_mul_f32 v104, v96, v104
    v_mul_f32 v105, v97, v105
    v_mul_f32 v106, v98, v106
    v_mul_f32 v107, v99, v107
    v_mfma_f32_32x32x16_bf16 v[112:127], v[148:151], v[16:19], v[112:127]
    s_setprio 0
    s_cmp_ge_u32 s56, 4
    s_cbranch_scc0 L_only_43
    s_waitcnt vmcnt(1)
    s_barrier
    s_setprio 3
L_only_43:
    v_mul_f32 v108, v100, v108
    v_mul_f32 v109, v101, v109
    v_mul_f32 v110, v102, v110
    v_mul_f32 v111, v103, v111
    v_fma_f32 v168, v168, v2, v2
    v_fma_f32 v169, v169, v2, v2
    v_fma_f32 v170, v170, v2, v2
    v_fma_f32 v171, v171, v2, v2
    v_fma_f32 v172, v172, v2, v2
    v_fma_f32 v173, v173, v2, v2
    v_fma_f32 v174, v174, v2, v2
    v_fma_f32 v175, v175, v2, v2
    v_rcp_f32 v168, v168
    v_rcp_f32 v169, v169
    v_rcp_f32 v170, v170
    v_rcp_f32 v171, v171
    v_rcp_f32 v172, v172
    v_rcp_f32 v173, v173
    v_rcp_f32 v174, v174
    v_rcp_f32 v175, v175
    v_mul_f32 v104, v104, v168
    v_mul_f32 v105, v105, v169
    v_mul_f32 v106, v106, v170
    v_mul_f32 v107, v107, v171
    v_mul_f32 v108, v108, v172
    v_mul_f32 v109, v109, v173
    v_mul_f32 v110, v110, v174
    v_mul_f32 v111, v111, v175
    v_cvt_pk_bf16_f32 v160, v104, v105
    v_cvt_pk_bf16_f32 v161, v106, v107
    v_cvt_pk_bf16_f32 v162, v108, v109
    v_cvt_pk_bf16_f32 v163, v110, v111
    buffer_store_dwordx4 v[160:163], v10, s[52:55], s66 offen offset:2048 sc1
    v_mul_f32 v168, v3, v112
    v_mul_f32 v169, v3, v113
    v_mul_f32 v170, v3, v114
    v_mul_f32 v171, v3, v115
    v_mul_f32 v172, v3, v116
    v_mul_f32 v173, v3, v117
    v_mul_f32 v174, v3, v118
    v_mul_f32 v175, v3, v119
    v_exp_f32 v168, v168
    v_exp_f32 v169, v169
    v_exp_f32 v170, v170
    v_exp_f32 v171, v171
    v_exp_f32 v172, v172
    v_exp_f32 v173, v173
    v_exp_f32 v174, v174
    v_exp_f32 v175, v175
    v_mul_f32 v120, v112, v120
    v_mul_f32 v121, v113, v121
    v_mul_f32 v122, v114, v122
    v_mul_f32 v123, v115, v123
    v_mul_f32 v124, v116, v124
    v_mul_f32 v125, v117, v125
    v_mul_f32 v126, v118, v126
    v_mul_f32 v127, v119, v127
    v_fma_f32 v168, v168, v2, v2
    v_fma_f32 v169, v169, v2, v2
    v_fma_f32 v170, v170, v2, v2
    v_fma_f32 v171, v171, v2, v2
    v_fma_f32 v172, v172, v2, v2
    v_fma_f32 v173, v173, v2, v2
    v_fma_f32 v174, v174, v2, v2
    v_fma_f32 v175, v175, v2, v2
    v_rcp_f32 v168, v168
    v_rcp_f32 v169, v169
    v_rcp_f32 v170, v170
    v_rcp_f32 v171, v171
    v_rcp_f32 v172, v172
    v_rcp_f32 v173, v173
    v_rcp_f32 v174, v174
    v_rcp_f32 v175, v175
    v_mul_f32 v120, v120, v168
    v_mul_f32 v121, v121, v169
    v_mul_f32 v122, v122, v170
    v_mul_f32 v123, v123, v171
    v_mul_f32 v124, v124, v172
    v_mul_f32 v125, v125, v173
    v_mul_f32 v126, v126, v174
    v_mul_f32 v127, v127, v175
    v_cvt_pk_bf16_f32 v164, v120, v121
    v_cvt_pk_bf16_f32 v165, v122, v123
    v_cvt_pk_bf16_f32 v166, v124, v125
    v_cvt_pk_bf16_f32 v167, v126, v127
    buffer_store_dwordx4 v[164:167], v10, s[52:55], s66 offen offset:3072 sc1
    s_cmp_ge_u32 s56, 4
    s_cbranch_scc1 L_only_44
    s_waitcnt vmcnt(3)
    s_barrier
    s_setprio 3
L_only_44:
    s_branch L_updone
L_noup:
    v_dot2_f32_bf16 v96, v128, s83, 0
    v_dot2_f32_bf16 v97, v128, s3, 0
    v_dot2_f32_bf16 v98, v129, s83, 0
    v_dot2_f32_bf16 v99, v129, s3, 0
    v_dot2_f32_bf16 v100, v130, s83, 0
    v_dot2_f32_bf16 v101, v130, s3, 0
    v_dot2_f32_bf16 v102, v131, s83, 0
    v_dot2_f32_bf16 v103, v131, s3, 0
    v_dot2_f32_bf16 v96, v132, s83, v96
    v_dot2_f32_bf16 v97, v132, s3, v97
    v_dot2_f32_bf16 v98, v133, s83, v98
    v_dot2_f32_bf16 v99, v133, s3, v99
    v_dot2_f32_bf16 v100, v134, s83, v100
    v_dot2_f32_bf16 v101, v134, s3, v101
    v_dot2_f32_bf16 v102, v135, s83, v102
    v_dot2_f32_bf16 v103, v135, s3, v103
    v_dot2_f32_bf16 v96, v136, s83, v96
    v_dot2_f32_bf16 v97, v136, s3, v97
    v_dot2_f32_bf16 v98, v137, s83, v98
    v_dot2_f32_bf16 v99, v137, s3, v99
    v_dot2_f32_bf16 v100, v138, s83, v100
    v_dot2_f32_bf16 v101, v138, s3, v101
    v_dot2_f32_bf16 v102, v139, s83, v102
    v_dot2_f32_bf16 v103, v139, s3, v103
    v_dot2_f32_bf16 v96, v140, s83, v96
    v_dot2_f32_bf16 v97, v140, s3, v97
    v_dot2_f32_bf16 v98, v141, s83, v98
    v_dot2_f32_bf16 v99, v141, s3, v99
    v_dot2_f32_bf16 v100, v142, s83, v100
    v_dot2_f32_bf16 v101, v142, s3, v101
    v_dot2_f32_bf16 v102, v143, s83, v102
    v_dot2_f32_bf16 v103, v143, s3, v103
    v_dot2_f32_bf16 v96, v144, s83, v96
    v_dot2_f32_bf16 v97, v144, s3, v97
    v_dot2_f32_bf16 v98, v145, s83, v98
    v_dot2_f32_bf16 v99, v145, s3, v99
    v_dot2_f32_bf16 v100, v146, s83, v100
    v_dot2_f32_bf16 v101, v146, s3, v101
    v_dot2_f32_bf16 v102, v147, s83, v102
    v_dot2_f32_bf16 v103, v147, s3, v103
    v_dot2_f32_bf16 v96, v148, s83, v96
    v_dot2_f32_bf16 v97, v148, s3, v97
    v_dot2_f32_bf16 v98, v149, s83, v98
    v_dot2_f32_bf16 v99, v149, s3, v99
    v_dot2_f32_bf16 v100, v150, s83, v100
    v_dot2_f32_bf16 v101, v150, s3, v101
    v_dot2_f32_bf16 v102, v151, s83, v102
    v_dot2_f32_bf16 v103, v151, s3, v103
    v_dot2_f32_bf16 v96, v152, s83, v96
    v_dot2_f32_bf16 v97, v152, s3, v97
    v_dot2_f32_bf16 v98, v153, s83, v98
    v_dot2_f32_bf16 v99, v153, s3, v99
    v_dot2_f32_bf16 v100, v154, s83, v100
    v_dot2_f32_bf16 v101, v154, s3, v101
    v_dot2_f32_bf16 v102, v155, s83, v102
    v_dot2_f32_bf16 v103, v155, s3, v103
    s_waitcnt vmcnt(8)
    v_dot2_f32_bf16 v96, v156, s83, v96
    v_dot2_f32_bf16 v97, v156, s3, v97
    v_dot2_f32_bf16 v98, v157, s83, v98
    v_dot2_f32_bf16 v99, v157, s3, v99
    v_dot2_f32_bf16 v100, v158, s83, v100
    v_dot2_f32_bf16 v101, v158, s3, v101
    v_dot2_f32_bf16 v102, v159, s83, v102
    v_dot2_f32_bf16 v103, v159, s3, v103
    s_waitcnt vmcnt(7)
    v_dot2_f32_bf16 v96, v160, s83, v96
    v_dot2_f32_bf16 v97, v160, s3, v97
    v_dot2_f32_bf16 v98, v161, s83, v98
    v_dot2_f32_bf16 v99, v161, s3, v99
    v_dot2_f32_bf16 v100, v162, s83, v100
    v_dot2_f32_bf16 v101, v162, s3, v101
    v_dot2_f32_bf16 v102, v163, s83, v102
    v_dot2_f32_bf16 v103, v163, s3, v103
    s_waitcnt vmcnt(6)
    v_dot2_f32_bf16 v96, v164, s83, v96
    v_dot2_f32_bf16 v97, v164, s3, v97
    v_dot2_f32_bf16 v98, v165, s83, v98
    v_dot2_f32_bf16 v99, v165, s3, v99
    v_dot2_f32_bf16 v100, v166, s83, v100
    v_dot2_f32_bf16 v101, v166, s3, v101
    v_dot2_f32_bf16 v102, v167, s83, v102
    v_dot2_f32_bf16 v103, v167, s3, v103
    s_waitcnt vmcnt(5)
    v_dot2_f32_bf16 v96, v168, s83, v96
    v_dot2_f32_bf16 v97, v168, s3, v97
    v_dot2_f32_bf16 v98, v169, s83, v98
    v_dot2_f32_bf16 v99, v169, s3, v99
    v_dot2_f32_bf16 v100, v170, s83, v100
    v_dot2_f32_bf16 v101, v170, s3, v101
    v_dot2_f32_bf16 v102, v171, s83, v102
    v_dot2_f32_bf16 v103, v171, s3, v103
    s_waitcnt vmcnt(4)
    v_dot2_f32_bf16 v96, v172, s83, v96
    v_dot2_f32_bf16 v97, v172, s3, v97
    v_dot2_f32_bf16 v98, v173, s83, v98
    v_dot2_f32_bf16 v99, v173, s3, v99
    v_dot2_f32_bf16 v100, v174, s83, v100
    v_dot2_f32_bf16 v101, v174, s3, v101
    v_dot2_f32_bf16 v102, v175, s83, v102
    v_dot2_f32_bf16 v103, v175, s3, v103
    s_waitcnt vmcnt(3)
    v_dot2_f32_bf16 v96, v176, s83, v96
    v_dot2_f32_bf16 v97, v176, s3, v97
    v_dot2_f32_bf16 v98, v177, s83, v98
    v_dot2_f32_bf16 v99, v177, s3, v99
    v_dot2_f32_bf16 v100, v178, s83, v100
    v_dot2_f32_bf16 v101, v178, s3, v101
    v_dot2_f32_bf16 v102, v179, s83, v102
    v_dot2_f32_bf16 v103, v179, s3, v103
    s_waitcnt vmcnt(2)
    v_dot2_f32_bf16 v96, v180, s83, v96
    v_dot2_f32_bf16 v97, v180, s3, v97
    v_dot2_f32_bf16 v98, v181, s83, v98
    v_dot2_f32_bf16 v99, v181, s3, v99
    v_dot2_f32_bf16 v100, v182, s83, v100
    v_dot2_f32_bf16 v101, v182, s3, v101
    v_dot2_f32_bf16 v102, v183, s83, v102
    v_dot2_f32_bf16 v103, v183, s3, v103
    s_waitcnt vmcnt(1)
    v_dot2_f32_bf16 v96, v184, s83, v96
    v_dot2_f32_bf16 v97, v184, s3, v97
    v_dot2_f32_bf16 v98, v185, s83, v98
    v_dot2_f32_bf16 v99, v185, s3, v99
    v_dot2_f32_bf16 v100, v186, s83, v100
    v_dot2_f32_bf16 v101, v186, s3, v101
    v_dot2_f32_bf16 v102, v187, s83, v102
    v_dot2_f32_bf16 v103, v187, s3, v103
    s_waitcnt vmcnt(0)
    v_dot2_f32_bf16 v96, v188, s83, v96
    v_dot2_f32_bf16 v97, v188, s3, v97
    v_dot2_f32_bf16 v98, v189, s83, v98
    v_dot2_f32_bf16 v99, v189, s3, v99
    v_dot2_f32_bf16 v100, v190, s83, v100
    v_dot2_f32_bf16 v101, v190, s3, v101
    v_dot2_f32_bf16 v102, v191, s83, v102
    v_dot2_f32_bf16 v103, v191, s3, v103
    v_lshlrev_b32 v104, 5, v0
    s_lshl_b32 s64, s56, 11
    v_add_u32 v104, s64, v104
    ds_write_b128 v104, v[96:99]
    ds_write_b128 v104, v[100:103] offset:16
    s_waitcnt lgkmcnt(0)
    s_barrier
    s_cmp_lt_u32 s56, 2
    s_cbranch_scc0 L_when_45
    v_lshlrev_b32 v104, 2, v0
    s_lshl_b32 s64, s56, 13
    v_add_u32 v104, s64, v104
    ds_read_b32 v128, v104 offset:0
    ds_read_b32 v129, v104 offset:256
    ds_read_b32 v130, v104 offset:512
    ds_read_b32 v131, v104 offset:768
    ds_read_b32 v132, v104 offset:1024
    ds_read_b32 v133, v104 offset:1280
    ds_read_b32 v134, v104 offset:1536
    ds_read_b32 v135, v104 offset:1792
    ds_read_b32 v136, v104 offset:2048
    ds_read_b32 v137, v104 offset:2304
    ds_read_b32 v138, v104 offset:2560
    ds_read_b32 v139, v104 offset:2816
    ds_read_b32 v140, v104 offset:3072
    ds_read_b32 v141, v104 offset:3328
    ds_read_b32 v142, v104 offset:3584
    ds_read_b32 v143, v104 offset:3840
    ds_read_b32 v144, v104 offset:4096
    ds_read_b32 v145, v104 offset:4352
    ds_read_b32 v146, v104 offset:4608
    ds_read_b32 v147, v104 offset:4864
    ds_read_b32 v148, v104 offset:5120
    ds_read_b32 v149, v104 offset:5376
    ds_read_b32 v150, v104 offset:5632
    ds_read_b32 v151, v104 offset:5888
    ds_read_b32 v152, v104 offset:6144
    ds_read_b32 v153, v104 offset:6400
    ds_read_b32 v154, v104 offset:6656
    ds_read_b32 v155, v104 offset:6912
    ds_read_b32 v156, v104 offset:7168
    ds_read_b32 v157, v104 offset:7424
    ds_read_b32 v158, v104 offset:7680
    ds_read_b32 v159, v104 offset:7936
    s_waitcnt lgkmcnt(15)
    v_add_f32 v128, v128, v144
    s_waitcnt lgkmcnt(14)
    v_add_f32 v129, v129, v145
    s_waitcnt lgkmcnt(13)
    v_add_f32 v130, v130, v146
    s_waitcnt lgkmcnt(12)
    v_add_f32 v131, v131, v147
    s_waitcnt lgkmcnt(11)
    v_add_f32 v132, v132, v148
    s_waitcnt lgkmcnt(10)
    v_add_f32 v133, v133, v149
    s_waitcnt lgkmcnt(9)
    v_add_f32 v134, v134, v150
    s_waitcnt lgkmcnt(8)
    v_add_f32 v135, v135, v151
    s_waitcnt lgkmcnt(7)
    v_add_f32 v136, v136, v152
    s_waitcnt lgkmcnt(6)
    v_add_f32 v137, v137, v153
    s_waitcnt lgkmcnt(5)
    v_add_f32 v138, v138, v154
    s_waitcnt lgkmcnt(4)
    v_add_f32 v139, v139, v155
    s_waitcnt lgkmcnt(3)
    v_add_f32 v140, v140, v156
    s_waitcnt lgkmcnt(2)
    v_add_f32 v141, v141, v157
    s_waitcnt lgkmcnt(1)
    v_add_f32 v142, v142, v158
    s_waitcnt lgkmcnt(0)
    v_add_f32 v143, v143, v159
    v_add_f32 v128, v128, v136
    v_add_f32 v129, v129, v137
    v_add_f32 v130, v130, v138
    v_add_f32 v131, v131, v139
    v_add_f32 v132, v132, v140
    v_add_f32 v133, v133, v141
    v_add_f32 v134, v134, v142
    v_add_f32 v135, v135, v143
    v_add_f32 v128, v128, v132
    v_add_f32 v129, v129, v133
    v_add_f32 v130, v130, v134
    v_add_f32 v131, v131, v135
    v_add_f32 v128, v128, v130
    v_add_f32 v129, v129, v131
    v_add_f32 v128, v128, v129
    v_lshrrev_b32 v104, 4, v0
    v_lshlrev_b32 v104, 7, v104
    v_and_b32 v105, 15, v0
    v_lshl_add_u32 v104, v105, 2, v104
    s_lshl_b32 s64, s21, 9
    s_lshl_b32 s65, s56, 6
    s_add_u32 s64, s64, s65
    s_add_u32 s64, s64, 0x1000
    buffer_store_dword v128, v104, s[52:55], s64 offen sc1
L_when_45:
    s_cmp_ge_u32 s56, 4
    s_cbranch_scc1 L_only_46
    s_add_u32 s64, s66, 0x10000
    buffer_store_dwordx4 v[20:23], v11, s[52:55], s64 offen sc1
    s_add_u32 s64, s66, 0x20000
    buffer_store_dwordx4 v[24:27], v11, s[52:55], s64 offen sc1
    s_add_u32 s64, s66, 0x30000
    buffer_store_dwordx4 v[28:31], v11, s[52:55], s64 offen sc1
L_only_46:
    s_cmp_ge_u32 s56, 4
    s_cbranch_scc0 L_only_47
    buffer_store_dwordx4 v[12:15], v11, s[52:55], s66 offen offset:0 sc1
    buffer_store_dwordx4 v[20:23], v11, s[52:55], s66 offen offset:512 sc1
L_only_47:
    s_cmp_lt_u32 s56, 2
    s_cbranch_scc0 L_when_48
    s_lshl_b32 s64, s21, 1
    s_add_u32 s64, s64, s56
    s_lshl_b32 s64, s64, 7
    s_add_u32 s64, s64, 0x6000
    s_waitcnt vmcnt(2)
    v_mov_b32 v104, s63
    v_mov_b32 v105, 0
    s_mov_b64 exec, 1
    buffer_store_dword v104, v105, s[52:55], s64 offen sc1
    s_mov_b64 exec, -1
L_when_48:
    s_waitcnt vmcnt(0)
    s_barrier
    s_cmp_lg_u32 s56, 0
    s_cbranch_scc1 L_nf_49
    s_lshr_b32 s64, s58, 1
    s_lshl_b32 s64, s64, 5
    s_lshl_b32 s65, s57, 1
    s_add_u32 s64, s64, s65
    s_add_u32 s64, s64, s82
    s_lshl_b32 s64, s64, 7
    s_add_u32 s64, s64, 0x8000
    v_mov_b32 v29, s63
    v_mov_b32 v30, 0
    s_mov_b64 exec, 1
    buffer_store_dword v29, v30, s[52:55], s64 offen sc1
    s_mov_b64 exec, -1
L_nf_49:
    v_and_b32 v29, 1, v0
    v_add_u32 v29, -1, v29
    v_and_b32 v24, s62, v29
    v_and_b32 v25, s62, v29
    v_and_b32 v26, s62, v29
    v_and_b32 v27, s62, v29
    v_and_b32 v13, 15, v0
    v_lshlrev_b32 v13, 7, v13
    v_and_b32 v23, 31, v0
    v_lshlrev_b32 v20, 2, v23
    s_lshr_b32 s64, s59, 2
    s_lshl_b32 s64, s64, 12
    s_add_u32 s64, s64, 0x8000
    v_lshl_add_u32 v23, v23, 7, s64
    s_lshl_b32 s65, s11, 9
    s_add_u32 s65, s65, 0x6000
    v_and_b32 v21, 3, v0
    v_lshl_add_u32 v21, v21, 7, s65
    v_and_b32 v29, 15, v0
    v_lshrrev_b32 v30, 5, v0
    v_lshl_add_u32 v30, v30, 4, v29
    v_lshlrev_b32 v30, 4, v30
    v_min_u32 v29, 1, v29
    v_lshlrev_b32 v29, 4, v29
    v_add_u32 v22, 0x1c100, v29
    v_add_u32 v11, 0x1bd00, v30
    v_and_b32 v29, 16, v0
    v_cmp_eq_u32 vcc, 16, v29
    v_add_u32 v15, 0x200, v11
    v_add_u32 v4, 0x1bd00, v10
    v_cndmask_b32 v11, v11, v22, vcc
    v_cndmask_b32 v22, v15, v22, vcc
    v_mov_b32 v14, 0xdddd
    v_lshrrev_b32 v29, 3, v0
    v_bfe_u32 v30, v0, 4, 1
    v_lshlrev_b32 v30, 2, v30
    v_and_b32 v15, 7, v0
    v_xor_b32 v30, v30, v15
    v_lshlrev_b32 v30, 4, v30
    v_lshl_add_u32 v12, v29, 10, v30
    s_lshr_b32 s64, s56, 1
    s_mul_i32 s64, s64, 0x70000
    s_and_b32 s65, s56, 1
    s_lshl_b32 s65, s65, 13
    s_add_u32 s64, s64, s65
    s_lshl_b32 s65, s60, 7
    s_add_u32 s64, s64, s65
    v_add_u32 v12, s64, v12
    v_mov_b32 v176, 0
    v_mov_b32 v177, 0
    v_mov_b32 v178, 0
    v_mov_b32 v179, 0
    v_mov_b32 v181, 0
    v_mov_b32 v182, 0
    v_mov_b32 v183, 0
    v_mov_b32 v184, 0
    v_mov_b32 v185, 0
    v_mov_b32 v186, 0
    v_mov_b32 v187, 0
    v_and_b32 v180, 0x3f80, v5
    v_mov_b32 v188, -1
    v_mov_b32 v189, -1
    v_mov_b32 v190, -1
    v_mov_b32 v191, -1
    v_mov_b32 v192, v5
    s_add_u32 s64, s76, 0x2400
    v_lshrrev_b32 v15, 1, v0
    v_mul_u32_u24 v15, 0x4100, v15
    v_and_b32 v29, 1, v0
    v_lshl_add_u32 v15, v29, 4, v15
    v_add_u32 v193, s64, v15
    s_cmp_eq_u32 s56, 1
    s_cbranch_scc0 L_when_50
    s_mov_b32 s68, 0
    buffer_load_dword v28, v23, s[52:55], s68 offen sc1
    s_waitcnt vmcnt(0)
    v_cmp_ne_u32 vcc, s63, v28
    s_cbranch_vccz L_ok_51
    s_mov_b32 s79, 0x40000
L_poll_52:
    buffer_load_dword v28, v23, s[52:55], s68 offen sc1
    s_waitcnt vmcnt(0)
    v_cmp_ne_u32 vcc, s63, v28
    s_cbranch_vccz L_ok_51
    s_sub_u32 s79, s79, 1
    s_cmp_lg_u32 s79, 0
    s_cbranch_scc1 L_poll_52
L_ok_51:
L_when_50:
    s_barrier
    s_lshl_b32 s64, s60, 13
    s_add_u32 s64, s64, s77
    s_add_u32 s64, s64, 0x60000
    buffer_load_dwordx4 v[128:131], v10, s[52:55], s64 offen sc1
    s_add_u32 m0, s75, 0x1bd00
    s_add_u32 s64, s60, 0
    s_and_b32 s64, s64, 7
    s_lshl_b32 s64, s64, 13
    s_add_u32 s64, s64, s77
    s_add_u32 s64, s64, 0x260000
    buffer_load_dwordx4 v10, s[52:55], s64 offen sc1 lds
    s_add_u32 m0, s76, 0x1dd00
    s_add_u32 s64, s60, 0
    s_and_b32 s64, s64, 7
    s_lshl_b32 s64, s64, 13
    s_add_u32 s64, s64, s77
    s_add_u32 s64, s64, 0x460000
    buffer_load_dwordx4 v10, s[52:55], s64 offen sc1 lds
    s_add_u32 m0, s75, 0x1fe00
    s_add_u32 s64, s60, 1
    s_and_b32 s64, s64, 7
    s_lshl_b32 s64, s64, 13
    s_add_u32 s64, s64, s77
    s_add_u32 s64, s64, 0x260000
    buffer_load_dwordx4 v10, s[52:55], s64 offen sc1 lds
    s_add_u32 m0, s76, 0x21e00
    s_add_u32 s64, s60, 1
    s_and_b32 s64, s64, 7
    s_lshl_b32 s64, s64, 13
    s_add_u32 s64, s64, s77
    s_add_u32 s64, s64, 0x460000
    buffer_load_dwordx4 v10, s[52:55], s64 offen sc1 lds
    s_add_u32 m0, s75, 0x23f00
    s_add_u32 s64, s60, 2
    s_and_b32 s64, s64, 7
    s_lshl_b32 s64, s64, 13
    s_add_u32 s64, s64, s77
    s_add_u32 s64, s64, 0x260000
    buffer_load_dwordx4 v10, s[52:55], s64 offen sc1 lds
    s_add_u32 m0, s76, 0x25f00
    s_add_u32 s64, s60, 2
    s_and_b32 s64, s64, 7
    s_lshl_b32 s64, s64, 13
    s_add_u32 s64, s64, s77
    s_add_u32 s64, s64, 0x460000
    buffer_load_dwordx4 v10, s[52:55], s64 offen sc1 lds
    s_add_u32 m0, s75, 0x10400
    s_add_u32 s64, s60, 3
    s_and_b32 s64, s64, 7
    s_lshl_b32 s64, s64, 13
    s_add_u32 s64, s64, s77
    s_add_u32 s64, s64, 0x260000
    buffer_load_dwordx4 v10, s[52:55], s64 offen sc1 lds
    s_add_u32 m0, s76, 0x12400
    s_add_u32 s64, s60, 3
    s_and_b32 s64, s64, 7
    s_lshl_b32 s64, s64, 13
    s_add_u32 s64, s64, s77
    s_add_u32 s64, s64, 0x460000
    buffer_load_dwordx4 v10, s[52:55], s64 offen sc1 lds
    s_add_u32 s64, s76, 0x1e100
    v_lshrrev_b32 v31, 1, v0
    v_mul_u32_u24 v31, 0x4100, v31
    v_and_b32 v29, 1, v0
    v_lshl_add_u32 v31, v29, 4, v31
    v_add_u32 v31, s64, v31
    s_mov_b64 exec, 63
    ds_write_b128 v31, v[24:27]
    s_mov_b64 exec, -1
    s_add_u32 s64, s76, 0x12800
    v_lshrrev_b32 v31, 1, v0
    v_mul_u32_u24 v31, 0x4100, v31
    v_and_b32 v29, 1, v0
    v_lshl_add_u32 v31, v29, 4, v31
    v_add_u32 v31, s64, v31
    s_mov_b64 exec, 3
    ds_write_b128 v31, v[24:27]
    s_mov_b64 exec, -1
    s_waitcnt vmcnt(0)
    s_waitcnt lgkmcnt(0)
    s_barrier
    s_setprio 3
L_updone:
    s_mov_b64 exec, 0xff
    ds_write_b128 v193, v[24:27]
    s_mov_b64 exec, -1
    v_mov_b32 v6, v22
    ds_read_b128 v[80:83], v4 offset:0
    ds_read_b128 v[84:87], v4 offset:1024
    ds_read_b128 v[88:91], v11 offset:8192
    ds_read_b128 v[96:99], v6 offset:8192
    ds_read_b128 v[92:95], v11 offset:9248
    s_waitcnt lgkmcnt(4)
    v_mfma_f32_32x32x16_bf16 v[16:31], v[80:83], v[128:131], 0
    s_waitcnt lgkmcnt(3)
    v_mfma_f32_32x32x16_bf16 v[32:47], v[84:87], v[128:131], 0
    v_mfma_f32_32x32x16_bf16 v[48:63], v[176:179], v[176:179], 0
    s_nop 8
    v_max3_f32 v7, v16, v17, v18
    v_max3_f32 v7, v19, v20, v7
    v_max3_f32 v7, v21, v22, v7
    v_max3_f32 v7, v23, v24, v7
    v_max3_f32 v7, v25, v26, v7
    v_max3_f32 v7, v27, v28, v7
    v_max3_f32 v7, v29, v30, v7
    v_max3_f32 v7, v31, v32, v7
    v_max3_f32 v7, v33, v34, v7
    v_max3_f32 v7, v35, v36, v7
    v_max3_f32 v7, v37, v38, v7
    v_max3_f32 v7, v39, v40, v7
    v_max3_f32 v7, v41, v42, v7
    v_max3_f32 v7, v43, v44, v7
    v_max3_f32 v7, v45, v46, v7
    v_max_f32 v7, v47, v7
    v_mov_b32 v8, v7
    s_nop 1
    v_permlane32_swap_b32 v7, v8
    v_max_f32 v7, v7, v8
    v_sub_f32 v7, 0xc2c80000, v7
    v_cvt_pk_bf16_f32 v7, v7, 0
    v_and_b32 v184, v192, v7
    s_nop 1
    v_mfma_f32_32x32x16_bf16 v[64:79], v[180:183], v[184:187], 0
    v_mfma_f32_32x32x16_bf16 v[16:31], v[80:83], v[128:131], v[64:79]
    ds_read_b128 v[80:83], v4 offset:2048
    s_mov_b32 s78, 0
    s_nop 9
    v_exp_f32 v16, v16
    v_exp_f32 v17, v17
    ds_read_b128 v[100:103], v6 offset:9248
    v_exp_f32 v18, v18
    v_exp_f32 v19, v19
    v_exp_f32 v20, v20
    v_mfma_f32_32x32x16_bf16 v[32:47], v[84:87], v[128:131], v[64:79]
    ds_read_b128 v[84:87], v4 offset:3072
    v_exp_f32 v21, v21
    v_exp_f32 v22, v22
    v_exp_f32 v23, v23
    v_exp_f32 v24, v24
    v_exp_f32 v25, v25
    s_waitcnt lgkmcnt(5)
    v_smfmac_f32_32x32x32_bf16 v[48:63], v[88:91], v[16:23], v14
    ds_read_b128 v[88:91], v11 offset:10304
    s_add_u32 m0, s75, 0
    s_add_u32 s64, s60, 4
    s_and_b32 s64, s64, 7
    s_lshl_b32 s64, s64, 13
    s_add_u32 s64, s64, s77
    s_add_u32 s64, s64, 0x260000
    buffer_load_dwordx4 v10, s[52:55], s64 offen sc1 lds
    v_exp_f32 v26, v26
    v_exp_f32 v27, v27
    v_exp_f32 v28, v28
    v_exp_f32 v29, v29
    v_exp_f32 v30, v30
    v_exp_f32 v31, v31
    v_exp_f32 v32, v32
    v_exp_f32 v33, v33
    s_waitcnt lgkmcnt(5)
    v_smfmac_f32_32x32x32_bf16 v[48:63], v[96:99], v[24:31], v14
    ds_read_b128 v[96:99], v6 offset:10304
    v_exp_f32 v34, v34
    v_exp_f32 v35, v35
    v_exp_f32 v36, v36
    s_waitcnt lgkmcnt(4)
    v_mfma_f32_32x32x16_bf16 v[16:31], v[80:83], v[128:131], v[64:79]
    ds_read_b128 v[80:83], v4 offset:4096
    v_exp_f32 v37, v37
    v_exp_f32 v38, v38
    v_exp_f32 v39, v39
    v_exp_f32 v40, v40
    v_exp_f32 v41, v41
    v_smfmac_f32_32x32x32_bf16 v[48:63], v[92:95], v[32:39], v14
    ds_read_b128 v[92:95], v11 offset:11360
    s_add_u32 m0, s76, 0x2000
    s_add_u32 s64, s60, 4
    s_and_b32 s64, s64, 7
    s_lshl_b32 s64, s64, 13
    s_add_u32 s64, s64, s77
    s_add_u32 s64, s64, 0x460000
    buffer_load_dwordx4 v10, s[52:55], s64 offen sc1 lds
    v_exp_f32 v42, v42
    v_exp_f32 v43, v43
    v_exp_f32 v44, v44
    v_exp_f32 v45, v45
    v_exp_f32 v46, v46
    v_exp_f32 v47, v47
    v_exp_f32 v16, v16
    v_exp_f32 v17, v17
    s_waitcnt lgkmcnt(3)
    v_smfmac_f32_32x32x32_bf16 v[48:63], v[100:103], v[40:47], v14
    ds_read_b128 v[100:103], v6 offset:11360
    v_exp_f32 v18, v18
    v_exp_f32 v19, v19
    v_exp_f32 v20, v20
    v_mfma_f32_32x32x16_bf16 v[32:47], v[84:87], v[128:131], v[64:79]
    ds_read_b128 v[84:87], v4 offset:5120
    v_exp_f32 v21, v21
    v_exp_f32 v22, v22
    v_exp_f32 v23, v23
    v_exp_f32 v24, v24
    v_exp_f32 v25, v25
    v_smfmac_f32_32x32x32_bf16 v[48:63], v[88:91], v[16:23], v14
    ds_read_b128 v[88:91], v11 offset:12416
    s_add_u32 m0, s75, 0x4100
    s_add_u32 s64, s60, 5
    s_and_b32 s64, s64, 7
    s_lshl_b32 s64, s64, 13
    s_add_u32 s64, s64, s77
    s_add_u32 s64, s64, 0x260000
    buffer_load_dwordx4 v10, s[52:55], s64 offen sc1 lds
    v_exp_f32 v26, v26
    v_exp_f32 v27, v27
    v_exp_f32 v28, v28
    v_exp_f32 v29, v29
    v_exp_f32 v30, v30
    v_exp_f32 v31, v31
    v_exp_f32 v32, v32
    v_exp_f32 v33, v33
    s_waitcnt lgkmcnt(3)
    v_smfmac_f32_32x32x32_bf16 v[48:63], v[96:99], v[24:31], v14
    ds_read_b128 v[96:99], v6 offset:12416
    v_exp_f32 v34, v34
    v_exp_f32 v35, v35
    v_exp_f32 v36, v36
    v_mfma_f32_32x32x16_bf16 v[16:31], v[80:83], v[128:131], v[64:79]
    ds_read_b128 v[80:83], v4 offset:6144
    v_exp_f32 v37, v37
    v_exp_f32 v38, v38
    v_exp_f32 v39, v39
    v_exp_f32 v40, v40
    v_exp_f32 v41, v41
    v_smfmac_f32_32x32x32_bf16 v[48:63], v[92:95], v[32:39], v14
    ds_read_b128 v[92:95], v11 offset:13472
    s_add_u32 m0, s76, 0x6100
    s_add_u32 s64, s60, 5
    s_and_b32 s64, s64, 7
    s_lshl_b32 s64, s64, 13
    s_add_u32 s64, s64, s77
    s_add_u32 s64, s64, 0x460000
    buffer_load_dwordx4 v10, s[52:55], s64 offen sc1 lds
    v_exp_f32 v42, v42
    v_exp_f32 v43, v43
    v_exp_f32 v44, v44
    v_exp_f32 v45, v45
    v_exp_f32 v46, v46
    v_exp_f32 v47, v47
    v_exp_f32 v16, v16
    v_exp_f32 v17, v17
    s_waitcnt lgkmcnt(3)
    v_smfmac_f32_32x32x32_bf16 v[48:63], v[100:103], v[40:47], v14
    ds_read_b128 v[100:103], v6 offset:13472
    v_exp_f32 v18, v18
    v_exp_f32 v19, v19
    v_exp_f32 v20, v20
    v_mfma_f32_32x32x16_bf16 v[32:47], v[84:87], v[128:131], v[64:79]
    ds_read_b128 v[84:87], v4 offset:7168
    v_exp_f32 v21, v21
    v_exp_f32 v22, v22
    v_exp_f32 v23, v23
    v_exp_f32 v24, v24
    v_exp_f32 v25, v25
    v_smfmac_f32_32x32x32_bf16 v[48:63], v[88:91], v[16:23], v14
    ds_read_b128 v[88:91], v11 offset:14528
    s_add_u32 m0, s75, 0x8200
    s_add_u32 s64, s60, 6
    s_and_b32 s64, s64, 7
    s_lshl_b32 s64, s64, 13
    s_add_u32 s64, s64, s77
    s_add_u32 s64, s64, 0x260000
    buffer_load_dwordx4 v10, s[52:55], s64 offen sc1 lds
    v_exp_f32 v26, v26
    v_exp_f32 v27, v27
    v_exp_f32 v28, v28
    v_exp_f32 v29, v29
    v_exp_f32 v30, v30
    v_exp_f32 v31, v31
    v_exp_f32 v32, v32
    v_exp_f32 v33, v33
    s_waitcnt lgkmcnt(3)
    v_smfmac_f32_32x32x32_bf16 v[48:63], v[96:99], v[24:31], v14
    ds_read_b128 v[96:99], v6 offset:14528
    v_exp_f32 v34, v34
    v_exp_f32 v35, v35
    v_exp_f32 v36, v36
    v_mfma_f32_32x32x16_bf16 v[16:31], v[80:83], v[128:131], v[64:79]
    ds_read_b128 v[80:83], v4 offset:16640
    v_exp_f32 v37, v37
    v_exp_f32 v38, v38
    v_exp_f32 v39, v39
    v_exp_f32 v40, v40
    v_exp_f32 v41, v41
    v_smfmac_f32_32x32x32_bf16 v[48:63], v[92:95], v[32:39], v14
    ds_read_b128 v[92:95], v11 offset:15584
    s_add_u32 m0, s76, 0xa200
    s_add_u32 s64, s60, 6
    s_and_b32 s64, s64, 7
    s_lshl_b32 s64, s64, 13
    s_add_u32 s64, s64, s77
    s_add_u32 s64, s64, 0x460000
    buffer_load_dwordx4 v10, s[52:55], s64 offen sc1 lds
    v_exp_f32 v42, v42
    v_exp_f32 v43, v43
    v_exp_f32 v44, v44
    v_exp_f32 v45, v45
    v_exp_f32 v46, v46
    v_exp_f32 v47, v47
    v_exp_f32 v16, v16
    v_exp_f32 v17, v17
    s_waitcnt lgkmcnt(3)
    v_smfmac_f32_32x32x32_bf16 v[48:63], v[100:103], v[40:47], v14
    ds_read_b128 v[100:103], v6 offset:15584
    v_exp_f32 v18, v18
    v_exp_f32 v19, v19
    v_exp_f32 v20, v20
    v_mfma_f32_32x32x16_bf16 v[32:47], v[84:87], v[128:131], v[64:79]
    ds_read_b128 v[84:87], v4 offset:17664
    v_exp_f32 v21, v21
    v_exp_f32 v22, v22
    v_exp_f32 v23, v23
    v_exp_f32 v24, v24
    v_exp_f32 v25, v25
    v_smfmac_f32_32x32x32_bf16 v[48:63], v[88:91], v[16:23], v14
    ds_read_b128 v[88:91], v11 offset:24832
    s_add_u32 m0, s75, 0xc300
    s_add_u32 s64, s60, 7
    s_and_b32 s64, s64, 7
    s_lshl_b32 s64, s64, 13
    s_add_u32 s64, s64, s77
    s_add_u32 s64, s64, 0x260000
    buffer_load_dwordx4 v10, s[52:55], s64 offen sc1 lds
    v_exp_f32 v26, v26
    v_exp_f32 v27, v27
    v_exp_f32 v28, v28
    v_exp_f32 v29, v29
    v_exp_f32 v30, v30
    v_exp_f32 v31, v31
    v_exp_f32 v32, v32
    v_exp_f32 v33, v33
    s_waitcnt lgkmcnt(3)
    v_smfmac_f32_32x32x32_bf16 v[48:63], v[96:99], v[24:31], v14
    ds_read_b128 v[96:99], v6 offset:24832
    v_exp_f32 v34, v34
    v_exp_f32 v35, v35
    v_exp_f32 v36, v36
    v_mfma_f32_32x32x16_bf16 v[16:31], v[80:83], v[128:131], v[64:79]
    ds_read_b128 v[80:83], v4 offset:18688
    v_exp_f32 v37, v37
    v_exp_f32 v38, v38
    v_exp_f32 v39, v39
    v_exp_f32 v40, v40
    v_exp_f32 v41, v41
    v_smfmac_f32_32x32x32_bf16 v[48:63], v[92:95], v[32:39], v14
    ds_read_b128 v[92:95], v11 offset:25888
    s_add_u32 m0, s76, 0xe300
    s_add_u32 s64, s60, 7
    s_and_b32 s64, s64, 7
    s_lshl_b32 s64, s64, 13
    s_add_u32 s64, s64, s77
    s_add_u32 s64, s64, 0x460000
    buffer_load_dwordx4 v10, s[52:55], s64 offen sc1 lds
    v_exp_f32 v42, v42
    v_exp_f32 v43, v43
    v_exp_f32 v44, v44
    v_exp_f32 v45, v45
    v_exp_f32 v46, v46
    v_exp_f32 v47, v47
    v_exp_f32 v16, v16
    v_exp_f32 v17, v17
    s_waitcnt lgkmcnt(3)
    v_smfmac_f32_32x32x32_bf16 v[48:63], v[100:103], v[40:47], v14
    ds_read_b128 v[100:103], v6 offset:25888
    v_exp_f32 v18, v18
    v_exp_f32 v19, v19
    v_exp_f32 v20, v20
    v_mfma_f32_32x32x16_bf16 v[32:47], v[84:87], v[128:131], v[64:79]
    ds_read_b128 v[84:87], v4 offset:19712
    v_exp_f32 v21, v21
    v_exp_f32 v22, v22
    v_exp_f32 v23, v23
    v_exp_f32 v24, v24
    v_exp_f32 v25, v25
    v_smfmac_f32_32x32x32_bf16 v[48:63], v[88:91], v[16:23], v14
    ds_read_b128 v[88:91], v11 offset:26944
    s_add_u32 m0, s75, 0x14500
    s_lshl_b32 s74, s10, 14
    buffer_load_dwordx4 v12, s[44:47], s74 offen lds
    v_exp_f32 v26, v26
    v_exp_f32 v27, v27
    v_exp_f32 v28, v28
    v_exp_f32 v29, v29
    v_exp_f32 v30, v30
    v_exp_f32 v31, v31
    v_exp_f32 v32, v32
    v_exp_f32 v33, v33
    s_waitcnt lgkmcnt(3)
    v_smfmac_f32_32x32x32_bf16 v[48:63], v[96:99], v[24:31], v14
    ds_read_b128 v[96:99], v6 offset:26944
    v_exp_f32 v34, v34
    v_exp_f32 v35, v35
    v_exp_f32 v36, v36
    v_mfma_f32_32x32x16_bf16 v[16:31], v[80:83], v[128:131], v[64:79]
    ds_read_b128 v[80:83], v4 offset:20736
    v_exp_f32 v37, v37
    v_exp_f32 v38, v38
    v_exp_f32 v39, v39
    v_exp_f32 v40, v40
    v_exp_f32 v41, v41
    v_smfmac_f32_32x32x32_bf16 v[48:63], v[92:95], v[32:39], v14
    ds_read_b128 v[92:95], v11 offset:28000
    s_add_u32 m0, s75, 0x16500
    s_add_u32 s74, s74, 0x4000
    s_cmp_eq_u32 s74, 0x70000
    s_cselect_b32 s74, 0, s74
    buffer_load_dwordx4 v12, s[44:47], s74 offen lds
    v_exp_f32 v42, v42
    v_exp_f32 v43, v43
    v_exp_f32 v44, v44
    v_exp_f32 v45, v45
    v_exp_f32 v46, v46
    v_exp_f32 v47, v47
    v_exp_f32 v16, v16
    v_exp_f32 v17, v17
    s_waitcnt lgkmcnt(3)
    v_smfmac_f32_32x32x32_bf16 v[48:63], v[100:103], v[40:47], v14
    ds_read_b128 v[100:103], v6 offset:28000
    v_exp_f32 v18, v18
    v_exp_f32 v19, v19
    v_exp_f32 v20, v20
    v_mfma_f32_32x32x16_bf16 v[32:47], v[84:87], v[128:131], v[64:79]
    ds_read_b128 v[84:87], v4 offset:21760
    v_exp_f32 v21, v21
    v_exp_f32 v22, v22
    v_exp_f32 v23, v23
    v_exp_f32 v24, v24
    v_exp_f32 v25, v25
    v_smfmac_f32_32x32x32_bf16 v[48:63], v[88:91], v[16:23], v14
    ds_read_b128 v[88:91], v11 offset:29056
    s_add_u32 m0, s75, 0x18500
    s_add_u32 s74, s74, 0x4000
    s_cmp_eq_u32 s74, 0x70000
    s_cselect_b32 s74, 0, s74
    buffer_load_dwordx4 v12, s[44:47], s74 offen lds
    v_exp_f32 v26, v26
    v_exp_f32 v27, v27
    v_exp_f32 v28, v28
    v_exp_f32 v29, v29
    v_exp_f32 v30, v30
    v_exp_f32 v31, v31
    v_exp_f32 v32, v32
    v_exp_f32 v33, v33
    s_waitcnt lgkmcnt(3)
    v_smfmac_f32_32x32x32_bf16 v[48:63], v[96:99], v[24:31], v14
    ds_read_b128 v[96:99], v6 offset:29056
    v_exp_f32 v34, v34
    v_exp_f32 v35, v35
    v_exp_f32 v36, v36
    v_mfma_f32_32x32x16_bf16 v[16:31], v[80:83], v[128:131], v[64:79]
    ds_read_b128 v[80:83], v4 offset:22784
    v_exp_f32 v37, v37
    v_exp_f32 v38, v38
    v_exp_f32 v39, v39
    v_exp_f32 v40, v40
    v_exp_f32 v41, v41
    v_smfmac_f32_32x32x32_bf16 v[48:63], v[92:95], v[32:39], v14
    ds_read_b128 v[92:95], v11 offset:30112
    v_exp_f32 v42, v42
    v_exp_f32 v43, v43
    v_exp_f32 v44, v44
    v_exp_f32 v45, v45
    v_exp_f32 v46, v46
    v_exp_f32 v47, v47
    v_exp_f32 v16, v16
    v_exp_f32 v17, v17
    s_waitcnt lgkmcnt(3)
    v_smfmac_f32_32x32x32_bf16 v[48:63], v[100:103], v[40:47], v14
    ds_read_b128 v[100:103], v6 offset:30112
    v_exp_f32 v18, v18
    v_exp_f32 v19, v19
    v_exp_f32 v20, v20
    v_mfma_f32_32x32x16_bf16 v[32:47], v[84:87], v[128:131], v[64:79]
    ds_read_b128 v[84:87], v4 offset:23808
    v_exp_f32 v21, v21
    v_exp_f32 v22, v22
    v_exp_f32 v23, v23
    v_exp_f32 v24, v24
    v_exp_f32 v25, v25
    v_smfmac_f32_32x32x32_bf16 v[48:63], v[88:91], v[16:23], v14
    ds_read_b128 v[88:91], v11 offset:31168
    v_exp_f32 v26, v26
    v_exp_f32 v27, v27
    v_exp_f32 v28, v28
    v_exp_f32 v29, v29
    v_exp_f32 v30, v30
    v_exp_f32 v31, v31
    v_exp_f32 v32, v32
    v_exp_f32 v33, v33
    s_waitcnt lgkmcnt(3)
    v_smfmac_f32_32x32x32_bf16 v[48:63], v[96:99], v[24:31], v14
    ds_read_b128 v[96:99], v6 offset:31168
    v_exp_f32 v34, v34
    v_exp_f32 v35, v35
    v_exp_f32 v36, v36
    v_mfma_f32_32x32x16_bf16 v[16:31], v[80:83], v[128:131], v[64:79]
    ds_read_b128 v[80:83], v4 offset:33280
    v_exp_f32 v37, v37
    v_exp_f32 v38, v38
    v_exp_f32 v39, v39
    v_exp_f32 v40, v40
    v_exp_f32 v41, v41
    v_smfmac_f32_32x32x32_bf16 v[48:63], v[92:95], v[32:39], v14
    ds_read_b128 v[92:95], v11 offset:32224
    v_exp_f32 v42, v42
    v_exp_f32 v43, v43
    v_exp_f32 v44, v44
    v_exp_f32 v45, v45
    v_exp_f32 v46, v46
    v_exp_f32 v47, v47
    v_exp_f32 v16, v16
    v_exp_f32 v17, v17
    s_waitcnt lgkmcnt(3)
    v_smfmac_f32_32x32x32_bf16 v[48:63], v[100:103], v[40:47], v14
    ds_read_b128 v[100:103], v6 offset:32224
    v_exp_f32 v18, v18
    v_exp_f32 v19, v19
    v_exp_f32 v20, v20
    v_mfma_f32_32x32x16_bf16 v[32:47], v[84:87], v[128:131], v[64:79]
    ds_read_b128 v[84:87], v4 offset:34304
    v_exp_f32 v21, v21
    v_exp_f32 v22, v22
    v_exp_f32 v23, v23
    v_exp_f32 v24, v24
    v_exp_f32 v25, v25
    v_smfmac_f32_32x32x32_bf16 v[48:63], v[88:91], v[16:23], v14
    ds_read_b128 v[88:91], v11 offset:41472
    v_exp_f32 v26, v26
    v_exp_f32 v27, v27
    v_exp_f32 v28, v28
    v_exp_f32 v29, v29
    v_exp_f32 v30, v30
    v_exp_f32 v31, v31
    v_exp_f32 v32, v32
    v_exp_f32 v33, v33
    s_waitcnt lgkmcnt(3)
    v_smfmac_f32_32x32x32_bf16 v[48:63], v[96:99], v[24:31], v14
    ds_read_b128 v[96:99], v6 offset:41472
    v_exp_f32 v34, v34
    v_exp_f32 v35, v35
    v_exp_f32 v36, v36
    v_mfma_f32_32x32x16_bf16 v[16:31], v[80:83], v[128:131], v[64:79]
    ds_read_b128 v[80:83], v4 offset:35328
    v_exp_f32 v37, v37
    v_exp_f32 v38, v38
    v_exp_f32 v39, v39
    v_exp_f32 v40, v40
    v_exp_f32 v41, v41
    v_smfmac_f32_32x32x32_bf16 v[48:63], v[92:95], v[32:39], v14
    ds_read_b128 v[92:95], v11 offset:42528
    v_exp_f32 v42, v42
    v_exp_f32 v43, v43
    v_exp_f32 v44, v44
    v_exp_f32 v45, v45
    v_exp_f32 v46, v46
    v_exp_f32 v47, v47
    v_exp_f32 v16, v16
    v_exp_f32 v17, v17
    s_waitcnt lgkmcnt(3)
    v_smfmac_f32_32x32x32_bf16 v[48:63], v[100:103], v[40:47], v14
    ds_read_b128 v[100:103], v6 offset:42528
    v_exp_f32 v18, v18
    v_exp_f32 v19, v19
    v_exp_f32 v20, v20
    v_mfma_f32_32x32x16_bf16 v[32:47], v[84:87], v[128:131], v[64:79]
    ds_read_b128 v[84:87], v4 offset:36352
    v_exp_f32 v21, v21
    v_exp_f32 v22, v22
    v_exp_f32 v23, v23
    v_exp_f32 v24, v24
    v_exp_f32 v25, v25
    v_smfmac_f32_32x32x32_bf16 v[48:63], v[88:91], v[16:23], v14
    ds_read_b128 v[88:91], v11 offset:43584
    v_exp_f32 v26, v26
    v_exp_f32 v27, v27
    v_exp_f32 v28, v28
    v_exp_f32 v29, v29
    v_exp_f32 v30, v30
    v_exp_f32 v31, v31
    v_exp_f32 v32, v32
    v_exp_f32 v33, v33
    s_waitcnt lgkmcnt(3)
    v_smfmac_f32_32x32x32_bf16 v[48:63], v[96:99], v[24:31], v14
    ds_read_b128 v[96:99], v6 offset:43584
    v_exp_f32 v34, v34
    v_exp_f32 v35, v35
    v_exp_f32 v36, v36
    v_mfma_f32_32x32x16_bf16 v[16:31], v[80:83], v[128:131], v[64:79]
    ds_read_b128 v[80:83], v4 offset:37376
    v_exp_f32 v37, v37
    v_exp_f32 v38, v38
    v_exp_f32 v39, v39
    v_exp_f32 v40, v40
    v_exp_f32 v41, v41
    v_smfmac_f32_32x32x32_bf16 v[48:63], v[92:95], v[32:39], v14
    ds_read_b128 v[92:95], v11 offset:44640
    v_exp_f32 v42, v42
    v_exp_f32 v43, v43
    v_exp_f32 v44, v44
    v_exp_f32 v45, v45
    v_exp_f32 v46, v46
    v_exp_f32 v47, v47
    s_setprio 2
    v_exp_f32 v16, v16
    v_exp_f32 v17, v17
    s_waitcnt lgkmcnt(3)
    v_smfmac_f32_32x32x32_bf16 v[48:63], v[100:103], v[40:47], v14
    ds_read_b128 v[100:103], v6 offset:44640
    v_exp_f32 v18, v18
    v_exp_f32 v19, v19
    v_exp_f32 v20, v20
    v_mfma_f32_32x32x16_bf16 v[32:47], v[84:87], v[128:131], v[64:79]
    ds_read_b128 v[84:87], v4 offset:38400
    s_lshl_b32 s64, s60, 3
    s_add_u32 s64, s64, s56
    s_lshl_b32 s64, s64, 5
    s_add_u32 s64, s64, s59
    s_lshl_b32 s64, s64, 10
    s_add_u32 s64, s64, 0x660000
    buffer_store_dwordx4 v[188:191], v10, s[52:55], s64 offen sc1
    v_exp_f32 v21, v21
    v_exp_f32 v22, v22
    v_exp_f32 v23, v23
    v_exp_f32 v24, v24
    v_exp_f32 v25, v25
    v_smfmac_f32_32x32x32_bf16 v[48:63], v[88:91], v[16:23], v14
    ds_read_b128 v[88:91], v11 offset:45696
    v_exp_f32 v26, v26
    v_exp_f32 v27, v27
    v_exp_f32 v28, v28
    v_exp_f32 v29, v29
    v_exp_f32 v30, v30
    v_exp_f32 v31, v31
    v_exp_f32 v32, v32
    v_exp_f32 v33, v33
    s_waitcnt lgkmcnt(3)
    v_smfmac_f32_32x32x32_bf16 v[48:63], v[96:99], v[24:31], v14
    ds_read_b128 v[96:99], v6 offset:45696
    v_exp_f32 v34, v34
    v_exp_f32 v35, v35
    v_exp_f32 v36, v36
    v_mfma_f32_32x32x16_bf16 v[16:31], v[80:83], v[128:131], v[64:79]
    ds_read_b128 v[80:83], v4 offset:39424
    v_exp_f32 v37, v37
    v_exp_f32 v38, v38
    v_exp_f32 v39, v39
    v_exp_f32 v40, v40
    v_exp_f32 v41, v41
    v_smfmac_f32_32x32x32_bf16 v[48:63], v[92:95], v[32:39], v14
    ds_read_b128 v[92:95], v11 offset:46752
    v_exp_f32 v42, v42
    v_exp_f32 v43, v43
    v_exp_f32 v44, v44
    v_exp_f32 v45, v45
    v_exp_f32 v46, v46
    v_exp_f32 v47, v47
    v_exp_f32 v16, v16
    v_exp_f32 v17, v17
    s_waitcnt lgkmcnt(3)
    v_smfmac_f32_32x32x32_bf16 v[48:63], v[100:103], v[40:47], v14
    ds_read_b128 v[100:103], v6 offset:46752
    v_exp_f32 v18, v18
    v_exp_f32 v19, v19
    v_exp_f32 v20, v20
    v_mfma_f32_32x32x16_bf16 v[32:47], v[84:87], v[128:131], v[64:79]
    ds_read_b128 v[84:87], v4 offset:40448
    v_exp_f32 v21, v21
    v_exp_f32 v22, v22
    v_exp_f32 v23, v23
    v_exp_f32 v24, v24
    v_exp_f32 v25, v25
    v_smfmac_f32_32x32x32_bf16 v[48:63], v[88:91], v[16:23], v14
    ds_read_b128 v[88:91], v11 offset:47808
    v_exp_f32 v26, v26
    v_exp_f32 v27, v27
    v_exp_f32 v28, v28
    v_exp_f32 v29, v29
    v_exp_f32 v30, v30
    v_exp_f32 v31, v31
    v_exp_f32 v32, v32
    v_exp_f32 v33, v33
    s_waitcnt lgkmcnt(3)
    v_smfmac_f32_32x32x32_bf16 v[48:63], v[96:99], v[24:31], v14
    ds_read_b128 v[96:99], v6 offset:47808
    v_exp_f32 v34, v34
    v_exp_f32 v35, v35
    v_exp_f32 v36, v36
    v_mfma_f32_32x32x16_bf16 v[16:31], v[80:83], v[128:131], v[64:79]
    v_add_u32 v4, 0xffff4700, v4
    ds_read_b128 v[80:83], v4 offset:0
    v_exp_f32 v37, v37
    v_exp_f32 v38, v38
    v_exp_f32 v39, v39
    v_exp_f32 v40, v40
    v_exp_f32 v41, v41
    v_smfmac_f32_32x32x32_bf16 v[48:63], v[92:95], v[32:39], v14
    ds_read_b128 v[92:95], v11 offset:48864
    v_exp_f32 v42, v42
    v_exp_f32 v43, v43
    v_exp_f32 v44, v44
    v_exp_f32 v45, v45
    v_exp_f32 v46, v46
    v_exp_f32 v47, v47
    v_exp_f32 v16, v16
    v_exp_f32 v17, v17
    s_waitcnt lgkmcnt(3)
    v_smfmac_f32_32x32x32_bf16 v[48:63], v[100:103], v[40:47], v14
    ds_read_b128 v[100:103], v6 offset:48864
    v_exp_f32 v18, v18
    v_exp_f32 v19, v19
    v_exp_f32 v20, v20
    v_mfma_f32_32x32x16_bf16 v[32:47], v[84:87], v[128:131], v[64:79]
    ds_read_b128 v[84:87], v4 offset:1024
    v_exp_f32 v21, v21
    v_exp_f32 v22, v22
    v_exp_f32 v23, v23
    v_exp_f32 v24, v24
    v_exp_f32 v25, v25
    v_smfmac_f32_32x32x32_bf16 v[48:63], v[88:91], v[16:23], v14
    v_add_u32 v11, 0xffff6700, v11
    ds_read_b128 v[88:91], v11 offset:0
    v_exp_f32 v26, v26
    v_exp_f32 v27, v27
    v_exp_f32 v28, v28
    v_exp_f32 v29, v29
    v_exp_f32 v30, v30
    v_exp_f32 v31, v31
    v_exp_f32 v32, v32
    v_exp_f32 v33, v33
    s_waitcnt lgkmcnt(3)
    v_smfmac_f32_32x32x32_bf16 v[48:63], v[96:99], v[24:31], v14
    v_add_u32 v6, 0xffff6700, v6
    ds_read_b128 v[96:99], v6 offset:0
    v_exp_f32 v34, v34
    v_exp_f32 v35, v35
    v_exp_f32 v36, v36
    v_mfma_f32_32x32x16_bf16 v[16:31], v[80:83], v[128:131], v[64:79]
    ds_read_b128 v[80:83], v4 offset:2048
    v_exp_f32 v37, v37
    v_exp_f32 v38, v38
    v_exp_f32 v39, v39
    v_exp_f32 v40, v40
    v_exp_f32 v41, v41
    v_smfmac_f32_32x32x32_bf16 v[48:63], v[92:95], v[32:39], v14
    ds_read_b128 v[92:95], v11 offset:1056
    v_exp_f32 v42, v42
    v_exp_f32 v43, v43
    v_exp_f32 v44, v44
    v_exp_f32 v45, v45
    v_exp_f32 v46, v46
    v_exp_f32 v47, v47
    v_exp_f32 v16, v16
    v_exp_f32 v17, v17
    s_waitcnt lgkmcnt(3)
    v_smfmac_f32_32x32x32_bf16 v[48:63], v[100:103], v[40:47], v14
    ds_read_b128 v[100:103], v6 offset:1056
    v_exp_f32 v18, v18
    v_exp_f32 v19, v19
    v_exp_f32 v20, v20
    v_mfma_f32_32x32x16_bf16 v[32:47], v[84:87], v[128:131], v[64:79]
    ds_read_b128 v[84:87], v4 offset:3072
    v_exp_f32 v21, v21
    v_exp_f32 v22, v22
    v_exp_f32 v23, v23
    v_exp_f32 v24, v24
    v_exp_f32 v25, v25
    v_smfmac_f32_32x32x32_bf16 v[48:63], v[88:91], v[16:23], v14
    ds_read_b128 v[88:91], v11 offset:2112
    v_exp_f32 v26, v26
    v_exp_f32 v27, v27
    v_exp_f32 v28, v28
    v_exp_f32 v29, v29
    v_exp_f32 v30, v30
    v_exp_f32 v31, v31
    v_exp_f32 v32, v32
    v_exp_f32 v33, v33
    s_waitcnt lgkmcnt(3)
    v_smfmac_f32_32x32x32_bf16 v[48:63], v[96:99], v[24:31], v14
    ds_read_b128 v[96:99], v6 offset:2112
    v_exp_f32 v34, v34
    v_exp_f32 v35, v35
    v_exp_f32 v36, v36
    v_mfma_f32_32x32x16_bf16 v[16:31], v[80:83], v[128:131], v[64:79]
    ds_read_b128 v[80:83], v4 offset:4096
    v_exp_f32 v37, v37
    v_exp_f32 v38, v38
    v_exp_f32 v39, v39
    v_exp_f32 v40, v40
    v_exp_f32 v41, v41
    v_smfmac_f32_32x32x32_bf16 v[48:63], v[92:95], v[32:39], v14
    ds_read_b128 v[92:95], v11 offset:3168
    v_exp_f32 v42, v42
    v_exp_f32 v43, v43
    v_exp_f32 v44, v44
    v_exp_f32 v45, v45
    v_exp_f32 v46, v46
    v_exp_f32 v47, v47
    s_setprio 1
    v_exp_f32 v16, v16
    v_exp_f32 v17, v17
    s_waitcnt lgkmcnt(3)
    v_smfmac_f32_32x32x32_bf16 v[48:63], v[100:103], v[40:47], v14
    ds_read_b128 v[100:103], v6 offset:3168
    v_exp_f32 v18, v18
    v_exp_f32 v19, v19
    v_exp_f32 v20, v20
    v_mfma_f32_32x32x16_bf16 v[32:47], v[84:87], v[128:131], v[64:79]
    ds_read_b128 v[84:87], v4 offset:5120
    v_exp_f32 v21, v21
    v_exp_f32 v22, v22
    v_exp_f32 v23, v23
    v_exp_f32 v24, v24
    v_exp_f32 v25, v25
    v_smfmac_f32_32x32x32_bf16 v[48:63], v[88:91], v[16:23], v14
    ds_read_b128 v[88:91], v11 offset:4224
    v_exp_f32 v26, v26
    v_exp_f32 v27, v27
    v_exp_f32 v28, v28
    v_exp_f32 v29, v29
    v_exp_f32 v30, v30
    v_exp_f32 v31, v31
    v_exp_f32 v32, v32
    v_exp_f32 v33, v33
    s_waitcnt lgkmcnt(3)
    v_smfmac_f32_32x32x32_bf16 v[48:63], v[96:99], v[24:31], v14
    ds_read_b128 v[96:99], v6 offset:4224
    v_exp_f32 v34, v34
    v_exp_f32 v35, v35
    v_exp_f32 v36, v36
    v_mfma_f32_32x32x16_bf16 v[16:31], v[80:83], v[128:131], v[64:79]
    ds_read_b128 v[80:83], v4 offset:6144
    v_exp_f32 v37, v37
    v_exp_f32 v38, v38
    v_exp_f32 v39, v39
    v_exp_f32 v40, v40
    v_exp_f32 v41, v41
    v_smfmac_f32_32x32x32_bf16 v[48:63], v[92:95], v[32:39], v14
    ds_read_b128 v[92:95], v11 offset:5280
    v_exp_f32 v42, v42
    v_exp_f32 v43, v43
    v_exp_f32 v44, v44
    v_exp_f32 v45, v45
    v_exp_f32 v46, v46
    v_exp_f32 v47, v47
    v_exp_f32 v16, v16
    v_exp_f32 v17, v17
    s_waitcnt lgkmcnt(3)
    v_smfmac_f32_32x32x32_bf16 v[48:63], v[100:103], v[40:47], v14
    ds_read_b128 v[100:103], v6 offset:5280
    v_exp_f32 v18, v18
    v_exp_f32 v19, v19
    v_exp_f32 v20, v20
    v_mfma_f32_32x32x16_bf16 v[32:47], v[84:87], v[128:131], v[64:79]
    ds_read_b128 v[84:87], v4 offset:7168
    v_exp_f32 v21, v21
    v_exp_f32 v22, v22
    v_exp_f32 v23, v23
    v_exp_f32 v24, v24
    v_exp_f32 v25, v25
    v_smfmac_f32_32x32x32_bf16 v[48:63], v[88:91], v[16:23], v14
    ds_read_b128 v[88:91], v11 offset:6336
    v_exp_f32 v26, v26
    v_exp_f32 v27, v27
    v_exp_f32 v28, v28
    v_exp_f32 v29, v29
    v_exp_f32 v30, v30
    v_exp_f32 v31, v31
    s_setprio 0
    v_exp_f32 v32, v32
    v_exp_f32 v33, v33
    s_waitcnt lgkmcnt(3)
    v_smfmac_f32_32x32x32_bf16 v[48:63], v[96:99], v[24:31], v14
    ds_read_b128 v[96:99], v6 offset:6336
    v_exp_f32 v34, v34
    v_exp_f32 v35, v35
    v_exp_f32 v36, v36
    v_mfma_f32_32x32x16_bf16 v[16:31], v[80:83], v[128:131], v[64:79]
    v_exp_f32 v37, v37
    v_exp_f32 v38, v38
    v_exp_f32 v39, v39
    v_exp_f32 v40, v40
    v_exp_f32 v41, v41
    v_smfmac_f32_32x32x32_bf16 v[48:63], v[92:95], v[32:39], v14
    ds_read_b128 v[92:95], v11 offset:7392
    v_exp_f32 v42, v42
    v_exp_f32 v43, v43
    v_exp_f32 v44, v44
    v_exp_f32 v45, v45
    v_exp_f32 v46, v46
    v_exp_f32 v47, v47
    v_exp_f32 v16, v16
    v_exp_f32 v17, v17
    s_waitcnt lgkmcnt(2)
    v_smfmac_f32_32x32x32_bf16 v[48:63], v[100:103], v[40:47], v14
    ds_read_b128 v[100:103], v6 offset:7392
    v_exp_f32 v18, v18
    v_exp_f32 v19, v19
    v_exp_f32 v20, v20
    v_mfma_f32_32x32x16_bf16 v[32:47], v[84:87], v[128:131], v[64:79]
    v_exp_f32 v21, v21
    v_exp_f32 v22, v22
    v_exp_f32 v23, v23
    v_exp_f32 v24, v24
    v_exp_f32 v25, v25
    v_smfmac_f32_32x32x32_bf16 v[48:63], v[88:91], v[16:23], v14
    s_waitcnt vmcnt(0)
    s_waitcnt lgkmcnt(0)
    s_barrier
    v_add_u32 v4, 0xfffefc00, v4
    ds_read_b128 v[80:83], v4 offset:0
    ds_read_b128 v[84:87], v4 offset:1024
    s_cmp_eq_u32 s56, 0
    s_cbranch_scc0 L_when_53
    s_lshl_b32 s64, s57, 4
    s_add_u32 s64, s64, s58
    s_lshl_b32 s64, s64, 7
    s_add_u32 s64, s64, 0x10000
    v_mov_b32 v7, s63
    v_mov_b32 v8, 0
    s_mov_b64 exec, 1
    buffer_store_dword v7, v8, s[52:55], s64 offen sc1
    s_mov_b64 exec, -1
    s_lshl_b32 s64, s60, 5
    s_add_u32 s64, s64, s59
    s_lshl_b32 s64, s64, 7
    s_add_u32 s64, s64, 0x20000
    v_mov_b32 v7, s63
    v_mov_b32 v8, 0
    s_mov_b64 exec, 1
    buffer_store_dword v7, v8, s[52:55], s64 offen sc1
    s_mov_b64 exec, -1
L_when_53:
    v_add_u32 v11, 0xfffefc00, v11
    ds_read_b128 v[88:91], v11 offset:0
    v_exp_f32 v26, v26
    v_exp_f32 v27, v27
    v_exp_f32 v28, v28
    v_exp_f32 v29, v29
    v_exp_f32 v30, v30
    v_exp_f32 v31, v31
    s_setprio 3
    v_exp_f32 v32, v32
    v_exp_f32 v33, v33
    v_smfmac_f32_32x32x32_bf16 v[48:63], v[96:99], v[24:31], v14
    v_add_u32 v6, 0xfffefc00, v6
    ds_read_b128 v[96:99], v6 offset:0
    v_exp_f32 v34, v34
    v_exp_f32 v35, v35
    v_exp_f32 v36, v36
    s_waitcnt lgkmcnt(3)
    v_mfma_f32_32x32x16_bf16 v[16:31], v[80:83], v[128:131], v[64:79]
    ds_read_b128 v[80:83], v4 offset:2048
    v_exp_f32 v37, v37
    v_exp_f32 v38, v38
    v_exp_f32 v39, v39
    v_exp_f32 v40, v40
    v_exp_f32 v41, v41
    v_smfmac_f32_32x32x32_bf16 v[48:63], v[92:95], v[32:39], v14
    ds_read_b128 v[92:95], v11 offset:1056
    s_add_u32 m0, s75, 0x10400
    s_add_u32 s74, s74, 0x4000
    s_cmp_eq_u32 s74, 0x70000
    s_cselect_b32 s74, 0, s74
    buffer_load_dwordx4 v12, s[44:47], s74 offen lds
    v_exp_f32 v42, v42
    v_exp_f32 v43, v43
    v_exp_f32 v44, v44
    v_exp_f32 v45, v45
    v_exp_f32 v46, v46
    v_exp_f32 v47, v47
    v_exp_f32 v16, v16
    v_exp_f32 v17, v17
    s_waitcnt lgkmcnt(3)
    v_smfmac_f32_32x32x32_bf16 v[48:63], v[100:103], v[40:47], v14
    ds_read_b128 v[100:103], v6 offset:1056
    v_exp_f32 v18, v18
    v_exp_f32 v19, v19
    v_exp_f32 v20, v20
    v_mfma_f32_32x32x16_bf16 v[32:47], v[84:87], v[128:131], v[64:79]
    ds_read_b128 v[84:87], v4 offset:3072
    v_exp_f32 v21, v21
    v_exp_f32 v22, v22
    v_exp_f32 v23, v23
    v_exp_f32 v24, v24
    v_exp_f32 v25, v25
    v_smfmac_f32_32x32x32_bf16 v[48:63], v[88:91], v[16:23], v14
    ds_read_b128 v[88:91], v11 offset:2112
    s_add_u32 m0, s75, 0x12400
    s_add_u32 s74, s74, 0x4000
    s_cmp_eq_u32 s74, 0x70000
    s_cselect_b32 s74, 0, s74
    buffer_load_dwordx4 v12, s[44:47], s74 offen lds
    v_exp_f32 v26, v26
    v_exp_f32 v27, v27
    v_exp_f32 v28, v28
    v_exp_f32 v29, v29
    v_exp_f32 v30, v30
    v_exp_f32 v31, v31
    v_exp_f32 v32, v32
    v_exp_f32 v33, v33
    s_waitcnt lgkmcnt(3)
    v_smfmac_f32_32x32x32_bf16 v[48:63], v[96:99], v[24:31], v14
    ds_read_b128 v[96:99], v6 offset:2112
    v_exp_f32 v34, v34
    v_exp_f32 v35, v35
    v_exp_f32 v36, v36
    v_mfma_f32_32x32x16_bf16 v[16:31], v[80:83], v[128:131], v[64:79]
    ds_read_b128 v[80:83], v4 offset:4096
    v_exp_f32 v37, v37
    v_exp_f32 v38, v38
    v_exp_f32 v39, v39
    v_exp_f32 v40, v40
    v_exp_f32 v41, v41
    v_smfmac_f32_32x32x32_bf16 v[48:63], v[92:95], v[32:39], v14
    ds_read_b128 v[92:95], v11 offset:3168
    s_add_u32 m0, s75, 0x1a500
    s_add_u32 s74, s74, 0x4000
    s_cmp_eq_u32 s74, 0x70000
    s_cselect_b32 s74, 0, s74
    buffer_load_dwordx4 v12, s[44:47], s74 offen lds
    v_exp_f32 v42, v42
    v_exp_f32 v43, v43
    v_exp_f32 v44, v44
    v_exp_f32 v45, v45
    v_exp_f32 v46, v46
    v_exp_f32 v47, v47
    v_exp_f32 v16, v16
    v_exp_f32 v17, v17
    s_waitcnt lgkmcnt(3)
    v_smfmac_f32_32x32x32_bf16 v[48:63], v[100:103], v[40:47], v14
    ds_read_b128 v[100:103], v6 offset:3168
    v_exp_f32 v18, v18
    v_exp_f32 v19, v19
    v_exp_f32 v20, v20
    v_mfma_f32_32x32x16_bf16 v[32:47], v[84:87], v[128:131], v[64:79]
    ds_read_b128 v[84:87], v4 offset:5120
    v_exp_f32 v21, v21
    v_exp_f32 v22, v22
    v_exp_f32 v23, v23
    v_exp_f32 v24, v24
    v_exp_f32 v25, v25
    v_smfmac_f32_32x32x32_bf16 v[48:63], v[88:91], v[16:23], v14
    ds_read_b128 v[88:91], v11 offset:4224
    s_add_u32 m0, s75, 0x1c500
    s_add_u32 s74, s74, 0x4000
    s_cmp_eq_u32 s74, 0x70000
    s_cselect_b32 s74, 0, s74
    buffer_load_dwordx4 v12, s[44:47], s74 offen lds
    v_exp_f32 v26, v26
    v_exp_f32 v27, v27
    v_exp_f32 v28, v28
    v_exp_f32 v29, v29
    v_exp_f32 v30, v30
    v_exp_f32 v31, v31
    v_exp_f32 v32, v32
    v_exp_f32 v33, v33
    s_waitcnt lgkmcnt(3)
    v_smfmac_f32_32x32x32_bf16 v[48:63], v[96:99], v[24:31], v14
    ds_read_b128 v[96:99], v6 offset:4224
    v_exp_f32 v34, v34
    v_exp_f32 v35, v35
    v_exp_f32 v36, v36
    v_mfma_f32_32x32x16_bf16 v[16:31], v[80:83], v[128:131], v[64:79]
    ds_read_b128 v[80:83], v4 offset:6144
    v_exp_f32 v37, v37
    v_exp_f32 v38, v38
    v_exp_f32 v39, v39
    v_exp_f32 v40, v40
    v_exp_f32 v41, v41
    v_smfmac_f32_32x32x32_bf16 v[48:63], v[92:95], v[32:39], v14
    ds_read_b128 v[92:95], v11 offset:5280
    s_add_u32 m0, s75, 0x1e500
    s_add_u32 s74, s74, 0x4000
    s_cmp_eq_u32 s74, 0x70000
    s_cselect_b32 s74, 0, s74
    buffer_load_dwordx4 v12, s[44:47], s74 offen lds
    v_exp_f32 v42, v42
    v_exp_f32 v43, v43
    v_exp_f32 v44, v44
    v_exp_f32 v45, v45
    v_exp_f32 v46, v46
    v_exp_f32 v47, v47
    v_exp_f32 v16, v16
    v_exp_f32 v17, v17
    s_waitcnt lgkmcnt(3)
    v_smfmac_f32_32x32x32_bf16 v[48:63], v[100:103], v[40:47], v14
    ds_read_b128 v[100:103], v6 offset:5280
    v_exp_f32 v18, v18
    v_exp_f32 v19, v19
    v_exp_f32 v20, v20
    v_mfma_f32_32x32x16_bf16 v[32:47], v[84:87], v[128:131], v[64:79]
    ds_read_b128 v[84:87], v4 offset:7168
    v_exp_f32 v21, v21
    v_exp_f32 v22, v22
    v_exp_f32 v23, v23
    v_exp_f32 v24, v24
    v_exp_f32 v25, v25
    v_smfmac_f32_32x32x32_bf16 v[48:63], v[88:91], v[16:23], v14
    ds_read_b128 v[88:91], v11 offset:6336
    s_add_u32 m0, s75, 0x20500
    s_add_u32 s74, s74, 0x4000
    s_cmp_eq_u32 s74, 0x70000
    s_cselect_b32 s74, 0, s74
    buffer_load_dwordx4 v12, s[44:47], s74 offen lds
    v_exp_f32 v26, v26
    v_exp_f32 v27, v27
    v_exp_f32 v28, v28
    v_exp_f32 v29, v29
    v_exp_f32 v30, v30
    v_exp_f32 v31, v31
    v_exp_f32 v32, v32
    v_exp_f32 v33, v33
    s_waitcnt lgkmcnt(3)
    v_smfmac_f32_32x32x32_bf16 v[48:63], v[96:99], v[24:31], v14
    ds_read_b128 v[96:99], v6 offset:6336
    v_exp_f32 v34, v34
    v_exp_f32 v35, v35
    v_exp_f32 v36, v36
    v_mfma_f32_32x32x16_bf16 v[16:31], v[80:83], v[128:131], v[64:79]
    ds_read_b128 v[80:83], v4 offset:16640
    v_exp_f32 v37, v37
    v_exp_f32 v38, v38
    v_exp_f32 v39, v39
    v_exp_f32 v40, v40
    v_exp_f32 v41, v41
    v_smfmac_f32_32x32x32_bf16 v[48:63], v[92:95], v[32:39], v14
    ds_read_b128 v[92:95], v11 offset:7392
    s_add_u32 m0, s75, 0x22500
    s_add_u32 s74, s74, 0x4000
    s_cmp_eq_u32 s74, 0x70000
    s_cselect_b32 s74, 0, s74
    buffer_load_dwordx4 v12, s[44:47], s74 offen lds
    v_exp_f32 v42, v42
    v_exp_f32 v43, v43
    v_exp_f32 v44, v44
    v_exp_f32 v45, v45
    v_exp_f32 v46, v46
    v_exp_f32 v47, v47
    v_exp_f32 v16, v16
    v_exp_f32 v17, v17
    s_waitcnt lgkmcnt(3)
    v_smfmac_f32_32x32x32_bf16 v[48:63], v[100:103], v[40:47], v14
    ds_read_b128 v[100:103], v6 offset:7392
    v_exp_f32 v18, v18
    v_exp_f32 v19, v19
    v_exp_f32 v20, v20
    v_mfma_f32_32x32x16_bf16 v[32:47], v[84:87], v[128:131], v[64:79]
    ds_read_b128 v[84:87], v4 offset:17664
    v_exp_f32 v21, v21
    v_exp_f32 v22, v22
    v_exp_f32 v23, v23
    v_exp_f32 v24, v24
    v_exp_f32 v25, v25
    v_smfmac_f32_32x32x32_bf16 v[48:63], v[88:91], v[16:23], v14
    ds_read_b128 v[88:91], v11 offset:16640
    s_add_u32 m0, s75, 0x24500
    s_add_u32 s74, s74, 0x4000
    s_cmp_eq_u32 s74, 0x70000
    s_cselect_b32 s74, 0, s74
    buffer_load_dwordx4 v12, s[44:47], s74 offen lds
    v_exp_f32 v26, v26
    v_exp_f32 v27, v27
    v_exp_f32 v28, v28
    v_exp_f32 v29, v29
    v_exp_f32 v30, v30
    v_exp_f32 v31, v31
    s_setprio 2
    v_exp_f32 v32, v32
    v_exp_f32 v33, v33
    s_waitcnt lgkmcnt(3)
    v_smfmac_f32_32x32x32_bf16 v[48:63], v[96:99], v[24:31], v14
    ds_read_b128 v[96:99], v6 offset:16640
    v_exp_f32 v34, v34
    v_exp_f32 v35, v35
    v_exp_f32 v36, v36
    v_mfma_f32_32x32x16_bf16 v[16:31], v[80:83], v[128:131], v[64:79]
    ds_read_b128 v[80:83], v4 offset:18688
    v_exp_f32 v37, v37
    v_exp_f32 v38, v38
    v_exp_f32 v39, v39
    v_exp_f32 v40, v40
    v_exp_f32 v41, v41
    v_smfmac_f32_32x32x32_bf16 v[48:63], v[92:95], v[32:39], v14
    ds_read_b128 v[92:95], v11 offset:17696
    v_exp_f32 v42, v42
    v_exp_f32 v43, v43
    v_exp_f32 v44, v44
    v_exp_f32 v45, v45
    v_exp_f32 v46, v46
    v_exp_f32 v47, v47
    v_exp_f32 v16, v16
    v_exp_f32 v17, v17
    s_waitcnt lgkmcnt(3)
    v_smfmac_f32_32x32x32_bf16 v[48:63], v[100:103], v[40:47], v14
    ds_read_b128 v[100:103], v6 offset:17696
    v_exp_f32 v18, v18
    v_exp_f32 v19, v19
    v_exp_f32 v20, v20
    v_mfma_f32_32x32x16_bf16 v[32:47], v[84:87], v[128:131], v[64:79]
    ds_read_b128 v[84:87], v4 offset:19712
    v_exp_f32 v21, v21
    v_exp_f32 v22, v22
    v_exp_f32 v23, v23
    v_exp_f32 v24, v24
    v_exp_f32 v25, v25
    v_smfmac_f32_32x32x32_bf16 v[48:63], v[88:91], v[16:23], v14
    ds_read_b128 v[88:91], v11 offset:18752
    v_exp_f32 v26, v26
    v_exp_f32 v27, v27
    v_exp_f32 v28, v28
    v_exp_f32 v29, v29
    v_exp_f32 v30, v30
    v_exp_f32 v31, v31
    v_exp_f32 v32, v32
    v_exp_f32 v33, v33
    s_waitcnt lgkmcnt(3)
    v_smfmac_f32_32x32x32_bf16 v[48:63], v[96:99], v[24:31], v14
    ds_read_b128 v[96:99], v6 offset:18752
    v_exp_f32 v34, v34
    v_exp_f32 v35, v35
    v_exp_f32 v36, v36
    v_mfma_f32_32x32x16_bf16 v[16:31], v[80:83], v[128:131], v[64:79]
    ds_read_b128 v[80:83], v4 offset:20736
    v_exp_f32 v37, v37
    v_exp_f32 v38, v38
    v_exp_f32 v39, v39
    v_exp_f32 v40, v40
    v_exp_f32 v41, v41
    v_smfmac_f32_32x32x32_bf16 v[48:63], v[92:95], v[32:39], v14
    ds_read_b128 v[92:95], v11 offset:19808
    v_exp_f32 v42, v42
    v_exp_f32 v43, v43
    v_exp_f32 v44, v44
    v_exp_f32 v45, v45
    v_exp_f32 v46, v46
    v_exp_f32 v47, v47
    v_exp_f32 v16, v16
    v_exp_f32 v17, v17
    s_waitcnt lgkmcnt(3)
    v_smfmac_f32_32x32x32_bf16 v[48:63], v[100:103], v[40:47], v14
    ds_read_b128 v[100:103], v6 offset:19808
    v_exp_f32 v18, v18
    v_exp_f32 v19, v19
    v_exp_f32 v20, v20
    v_mfma_f32_32x32x16_bf16 v[32:47], v[84:87], v[128:131], v[64:79]
    ds_read_b128 v[84:87], v4 offset:21760
    v_exp_f32 v21, v21
    v_exp_f32 v22, v22
    v_exp_f32 v23, v23
    v_exp_f32 v24, v24
    v_exp_f32 v25, v25
    v_smfmac_f32_32x32x32_bf16 v[48:63], v[88:91], v[16:23], v14
    ds_read_b128 v[88:91], v11 offset:20864
    v_exp_f32 v26, v26
    v_exp_f32 v27, v27
    v_exp_f32 v28, v28
    v_exp_f32 v29, v29
    v_exp_f32 v30, v30
    v_exp_f32 v31, v31
    s_setprio 1
    v_exp_f32 v32, v32
    v_exp_f32 v33, v33
    s_waitcnt lgkmcnt(3)
    v_smfmac_f32_32x32x32_bf16 v[48:63], v[96:99], v[24:31], v14
    ds_read_b128 v[96:99], v6 offset:20864
    v_exp_f32 v34, v34
    v_exp_f32 v35, v35
    v_exp_f32 v36, v36
    v_mfma_f32_32x32x16_bf16 v[16:31], v[80:83], v[128:131], v[64:79]
    ds_read_b128 v[80:83], v4 offset:22784
    s_lshr_b32 s64, s59, 1
    s_lshl_b32 s64, s64, 11
    s_add_u32 s64, s64, 0x10000
    v_add_u32 v9, s64, v13
    s_lshr_b32 s64, s59, 2
    s_lshl_b32 s64, s64, 12
    s_add_u32 s64, s64, 0x1f000
    v_lshl_add_u32 v7, v0, 7, s64
    v_cmp_gt_u32 vcc, 32, v0
    s_nop 1
    v_cndmask_b32 v9, v7, v9, vcc
    s_mov_b32 s68, 0
    s_cmp_eq_u32 s56, 1
    s_cbranch_scc0 L_when_54
    buffer_load_dword v15, v9, s[52:55], s68 offen sc1
L_when_54:
    v_exp_f32 v37, v37
    v_exp_f32 v38, v38
    v_exp_f32 v39, v39
    v_exp_f32 v40, v40
    v_exp_f32 v41, v41
    v_smfmac_f32_32x32x32_bf16 v[48:63], v[92:95], v[32:39], v14
    ds_read_b128 v[92:95], v11 offset:21920
    v_exp_f32 v42, v42
    v_exp_f32 v43, v43
    v_exp_f32 v44, v44
    v_exp_f32 v45, v45
    v_exp_f32 v46, v46
    v_exp_f32 v47, v47
    v_exp_f32 v16, v16
    v_exp_f32 v17, v17
    s_waitcnt lgkmcnt(3)
    v_smfmac_f32_32x32x32_bf16 v[48:63], v[100:103], v[40:47], v14
    ds_read_b128 v[100:103], v6 offset:21920
    v_exp_f32 v18, v18
    v_exp_f32 v19, v19
    v_exp_f32 v20, v20
    v_mfma_f32_32x32x16_bf16 v[32:47], v[84:87], v[128:131], v[64:79]
    ds_read_b128 v[84:87], v4 offset:23808
    v_exp_f32 v21, v21
    v_exp_f32 v22, v22
    v_exp_f32 v23, v23
    v_exp_f32 v24, v24
    v_exp_f32 v25, v25
    v_smfmac_f32_32x32x32_bf16 v[48:63], v[88:91], v[16:23], v14
    ds_read_b128 v[88:91], v11 offset:22976
    v_exp_f32 v26, v26
    v_exp_f32 v27, v27
    v_exp_f32 v28, v28
    v_exp_f32 v29, v29
    v_exp_f32 v30, v30
    v_exp_f32 v31, v31
    s_setprio 0
    v_exp_f32 v32, v32
    v_exp_f32 v33, v33
    s_waitcnt lgkmcnt(3)
    v_smfmac_f32_32x32x32_bf16 v[48:63], v[96:99], v[24:31], v14
    ds_read_b128 v[96:99], v6 offset:22976
    v_exp_f32 v34, v34
    v_exp_f32 v35, v35
    v_exp_f32 v36, v36
    v_mfma_f32_32x32x16_bf16 v[16:31], v[80:83], v[128:131], v[64:79]
    ds_read_b128 v[80:83], v4 offset:33280
    v_exp_f32 v37, v37
    v_exp_f32 v38, v38
    v_exp_f32 v39, v39
    v_exp_f32 v40, v40
    v_exp_f32 v41, v41
    v_smfmac_f32_32x32x32_bf16 v[48:63], v[92:95], v[32:39], v14
    ds_read_b128 v[92:95], v11 offset:24032
    v_exp_f32 v42, v42
    v_exp_f32 v43, v43
    v_exp_f32 v44, v44
    v_exp_f32 v45, v45
    v_exp_f32 v46, v46
    v_exp_f32 v47, v47
    v_exp_f32 v16, v16
    v_exp_f32 v17, v17
    s_waitcnt lgkmcnt(3)
    v_smfmac_f32_32x32x32_bf16 v[48:63], v[100:103], v[40:47], v14
    ds_read_b128 v[100:103], v6 offset:24032
    v_exp_f32 v18, v18
    v_exp_f32 v19, v19
    v_exp_f32 v20, v20
    v_mfma_f32_32x32x16_bf16 v[32:47], v[84:87], v[128:131], v[64:79]
    ds_read_b128 v[84:87], v4 offset:34304
    v_exp_f32 v21, v21
    v_exp_f32 v22, v22
    v_exp_f32 v23, v23
    v_exp_f32 v24, v24
    v_exp_f32 v25, v25
    v_smfmac_f32_32x32x32_bf16 v[48:63], v[88:91], v[16:23], v14
    s_cmp_eq_u32 s56, 1
    s_cbranch_scc0 L_when_55
    s_waitcnt vmcnt(0)
    v_cmp_ne_u32 vcc, s63, v15
    s_cbranch_vccz L_ok_56
    s_mov_b32 s79, 0x40000
L_poll_57:
    buffer_load_dword v15, v9, s[52:55], s68 offen sc1
    s_waitcnt vmcnt(0)
    v_cmp_ne_u32 vcc, s63, v15
    s_cbranch_vccz L_ok_56
    s_sub_u32 s79, s79, 1
    s_cmp_lg_u32 s79, 0
    s_cbranch_scc1 L_poll_57
L_ok_56:
L_when_55:
    s_waitcnt vmcnt(0)
    s_waitcnt lgkmcnt(0)
    s_barrier
    ds_read_b128 v[88:91], v11 offset:33280
    v_exp_f32 v26, v26
    v_exp_f32 v27, v27
    v_exp_f32 v28, v28
    v_exp_f32 v29, v29
    v_exp_f32 v30, v30
    v_exp_f32 v31, v31
    s_setprio 3
    v_exp_f32 v32, v32
    v_exp_f32 v33, v33
    v_smfmac_f32_32x32x32_bf16 v[48:63], v[96:99], v[24:31], v14
    ds_read_b128 v[96:99], v6 offset:33280
    v_exp_f32 v34, v34
    v_exp_f32 v35, v35
    v_exp_f32 v36, v36
    v_mfma_f32_32x32x16_bf16 v[16:31], v[80:83], v[128:131], v[64:79]
    ds_read_b128 v[80:83], v4 offset:35328
    s_lshl_b32 s64, s59, 1
    s_and_b32 s65, s56, 1
    s_add_u32 s64, s64, s65
    s_mul_i32 s64, s64, 0x70
    s_lshr_b32 s65, s56, 1
    s_mul_i32 s65, s65, 28
    s_add_u32 s64, s64, s65
    s_add_u32 s64, s64, s10
    s_lshl_b32 s64, s64, 10
    s_add_u32 s72, s64, 0x860000
    s_sub_u32 s73, s72, 0x7000
    s_cmp_ge_u32 s10, 28
    s_cselect_b32 s64, s73, s72
    buffer_load_dwordx4 v[144:147], v10, s[52:55], s64 offen offset:0 sc1
    v_exp_f32 v37, v37
    v_exp_f32 v38, v38
    v_exp_f32 v39, v39
    v_exp_f32 v40, v40
    v_exp_f32 v41, v41
    v_smfmac_f32_32x32x32_bf16 v[48:63], v[92:95], v[32:39], v14
    ds_read_b128 v[92:95], v11 offset:34336
    s_add_u32 m0, s75, 0
    s_add_u32 s74, s74, 0x4000
    s_cmp_eq_u32 s74, 0x70000
    s_cselect_b32 s74, 0, s74
    buffer_load_dwordx4 v12, s[44:47], s74 offen lds
    s_cmp_ge_u32 s10, 27
    s_cselect_b32 s64, s73, s72
    buffer_load_dwordx4 v[148:151], v10, s[52:55], s64 offen offset:1024 sc1
    v_exp_f32 v42, v42
    v_exp_f32 v43, v43
    v_exp_f32 v44, v44
    v_exp_f32 v45, v45
    v_exp_f32 v46, v46
    v_exp_f32 v47, v47
    v_exp_f32 v16, v16
    v_exp_f32 v17, v17
    s_waitcnt lgkmcnt(3)
    v_smfmac_f32_32x32x32_bf16 v[48:63], v[100:103], v[40:47], v14
    ds_read_b128 v[100:103], v6 offset:34336
    v_exp_f32 v18, v18
    v_exp_f32 v19, v19
    v_exp_f32 v20, v20
    v_mfma_f32_32x32x16_bf16 v[32:47], v[84:87], v[128:131], v[64:79]
    ds_read_b128 v[84:87], v4 offset:36352
    s_cmp_ge_u32 s10, 26
    s_cselect_b32 s64, s73, s72
    buffer_load_dwordx4 v[152:155], v10, s[52:55], s64 offen offset:2048 sc1
    v_exp_f32 v21, v21
    v_exp_f32 v22, v22
    v_exp_f32 v23, v23
    v_exp_f32 v24, v24
    v_exp_f32 v25, v25
    v_smfmac_f32_32x32x32_bf16 v[48:63], v[88:91], v[16:23], v14
    ds_read_b128 v[88:91], v11 offset:35392
    s_add_u32 m0, s75, 0x2000
    s_add_u32 s74, s74, 0x4000
    s_cmp_eq_u32 s74, 0x70000
    s_cselect_b32 s74, 0, s74
    buffer_load_dwordx4 v12, s[44:47], s74 offen lds
    s_cmp_ge_u32 s10, 25
    s_cselect_b32 s64, s73, s72
    buffer_load_dwordx4 v[156:159], v10, s[52:55], s64 offen offset:3072 sc1
    v_exp_f32 v26, v26
    v_exp_f32 v27, v27
    v_exp_f32 v28, v28
    v_exp_f32 v29, v29
    v_exp_f32 v30, v30
    v_exp_f32 v31, v31
    v_exp_f32 v32, v32
    v_exp_f32 v33, v33
    s_waitcnt lgkmcnt(3)
    v_smfmac_f32_32x32x32_bf16 v[48:63], v[96:99], v[24:31], v14
    ds_read_b128 v[96:99], v6 offset:35392
    v_exp_f32 v34, v34
    v_exp_f32 v35, v35
    v_exp_f32 v36, v36
    v_mfma_f32_32x32x16_bf16 v[16:31], v[80:83], v[128:131], v[64:79]
    ds_read_b128 v[80:83], v4 offset:37376
    s_add_u32 s72, s72, 0x1000
    s_add_u32 s73, s73, 0x1000
    s_cmp_ge_u32 s10, 24
    s_cselect_b32 s64, s73, s72
    buffer_load_dwordx4 v[160:163], v10, s[52:55], s64 offen offset:0 sc1
    v_exp_f32 v37, v37
    v_exp_f32 v38, v38
    v_exp_f32 v39, v39
    v_exp_f32 v40, v40
    v_exp_f32 v41, v41
    v_smfmac_f32_32x32x32_bf16 v[48:63], v[92:95], v[32:39], v14
    ds_read_b128 v[92:95], v11 offset:36448
    s_add_u32 m0, s75, 0x4000
    s_add_u32 s74, s74, 0x4000
    s_cmp_eq_u32 s74, 0x70000
    s_cselect_b32 s74, 0, s74
    buffer_load_dwordx4 v12, s[44:47], s74 offen lds
    s_cmp_ge_u32 s10, 23
    s_cselect_b32 s64, s73, s72
    buffer_load_dwordx4 v[164:167], v10, s[52:55], s64 offen offset:1024 sc1
    v_exp_f32 v42, v42
    v_exp_f32 v43, v43
    v_exp_f32 v44, v44
    v_exp_f32 v45, v45
    v_exp_f32 v46, v46
    v_exp_f32 v47, v47
    v_exp_f32 v16, v16
    v_exp_f32 v17, v17
    s_waitcnt lgkmcnt(3)
    v_smfmac_f32_32x32x32_bf16 v[48:63], v[100:103], v[40:47], v14
    ds_read_b128 v[100:103], v6 offset:36448
    v_exp_f32 v18, v18
    v_exp_f32 v19, v19
    v_exp_f32 v20, v20
    v_mfma_f32_32x32x16_bf16 v[32:47], v[84:87], v[128:131], v[64:79]
    ds_read_b128 v[84:87], v4 offset:38400
    s_cmp_ge_u32 s10, 22
    s_cselect_b32 s64, s73, s72
    buffer_load_dwordx4 v[168:171], v10, s[52:55], s64 offen offset:2048 sc1
    v_exp_f32 v21, v21
    v_exp_f32 v22, v22
    v_exp_f32 v23, v23
    v_exp_f32 v24, v24
    v_exp_f32 v25, v25
    v_smfmac_f32_32x32x32_bf16 v[48:63], v[88:91], v[16:23], v14
    ds_read_b128 v[88:91], v11 offset:37504
    s_add_u32 m0, s75, 0x6000
    s_add_u32 s74, s74, 0x4000
    s_cmp_eq_u32 s74, 0x70000
    s_cselect_b32 s74, 0, s74
    buffer_load_dwordx4 v12, s[44:47], s74 offen lds
    s_cmp_ge_u32 s10, 21
    s_cselect_b32 s64, s73, s72
    buffer_load_dwordx4 v[172:175], v10, s[52:55], s64 offen offset:3072 sc1
    v_exp_f32 v26, v26
    v_exp_f32 v27, v27
    v_exp_f32 v28, v28
    v_exp_f32 v29, v29
    v_exp_f32 v30, v30
    v_exp_f32 v31, v31
    v_exp_f32 v32, v32
    v_exp_f32 v33, v33
    s_waitcnt lgkmcnt(3)
    v_smfmac_f32_32x32x32_bf16 v[48:63], v[96:99], v[24:31], v14
    ds_read_b128 v[96:99], v6 offset:37504
    v_exp_f32 v34, v34
    v_exp_f32 v35, v35
    v_exp_f32 v36, v36
    v_mfma_f32_32x32x16_bf16 v[16:31], v[80:83], v[128:131], v[64:79]
    ds_read_b128 v[80:83], v4 offset:39424
    s_add_u32 s72, s72, 0x1000
    s_add_u32 s73, s73, 0x1000
    s_cmp_ge_u32 s10, 20
    s_cselect_b32 s64, s73, s72
    buffer_load_dwordx4 v[176:179], v10, s[52:55], s64 offen offset:0 sc1
    v_exp_f32 v37, v37
    v_exp_f32 v38, v38
    v_exp_f32 v39, v39
    v_exp_f32 v40, v40
    v_exp_f32 v41, v41
    v_smfmac_f32_32x32x32_bf16 v[48:63], v[92:95], v[32:39], v14
    ds_read_b128 v[92:95], v11 offset:38560
    s_cmp_ge_u32 s10, 19
    s_cselect_b32 s64, s73, s72
    buffer_load_dwordx4 v[180:183], v10, s[52:55], s64 offen offset:1024 sc1
    v_exp_f32 v42, v42
    v_exp_f32 v43, v43
    v_exp_f32 v44, v44
    v_exp_f32 v45, v45
    v_exp_f32 v46, v46
    v_exp_f32 v47, v47
    v_exp_f32 v16, v16
    v_exp_f32 v17, v17
    s_waitcnt lgkmcnt(3)
    v_smfmac_f32_32x32x32_bf16 v[48:63], v[100:103], v[40:47], v14
    ds_read_b128 v[100:103], v6 offset:38560
    v_exp_f32 v18, v18
    v_exp_f32 v19, v19
    v_exp_f32 v20, v20
    v_mfma_f32_32x32x16_bf16 v[32:47], v[84:87], v[128:131], v[64:79]
    ds_read_b128 v[84:87], v4 offset:40448
    s_cmp_ge_u32 s10, 18
    s_cselect_b32 s64, s73, s72
    buffer_load_dwordx4 v[184:187], v10, s[52:55], s64 offen offset:2048 sc1
    v_exp_f32 v21, v21
    v_exp_f32 v22, v22
    v_exp_f32 v23, v23
    v_exp_f32 v24, v24
    v_exp_f32 v25, v25
    v_smfmac_f32_32x32x32_bf16 v[48:63], v[88:91], v[16:23], v14
    ds_read_b128 v[88:91], v11 offset:39616
    s_cmp_ge_u32 s10, 17
    s_cselect_b32 s64, s73, s72
    buffer_load_dwordx4 v[188:191], v10, s[52:55], s64 offen offset:3072 sc1
    v_exp_f32 v26, v26
    v_exp_f32 v27, v27
    v_exp_f32 v28, v28
    v_exp_f32 v29, v29
    v_exp_f32 v30, v30
    v_exp_f32 v31, v31
    v_exp_f32 v32, v32
    v_exp_f32 v33, v33
    s_waitcnt lgkmcnt(3)
    v_smfmac_f32_32x32x32_bf16 v[48:63], v[96:99], v[24:31], v14
    ds_read_b128 v[96:99], v6 offset:39616
    v_exp_f32 v34, v34
    v_exp_f32 v35, v35
    v_exp_f32 v36, v36
    v_mfma_f32_32x32x16_bf16 v[16:31], v[80:83], v[128:131], v[64:79]
    ds_read_b128 v[80:83], v4 offset:49920
    s_add_u32 s72, s72, 0x1000
    s_add_u32 s73, s73, 0x1000
    s_cmp_ge_u32 s10, 16
    s_cselect_b32 s64, s73, s72
    buffer_load_dwordx4 v[192:195], v10, s[52:55], s64 offen offset:0 sc1
    v_exp_f32 v37, v37
    v_exp_f32 v38, v38
    v_exp_f32 v39, v39
    v_exp_f32 v40, v40
    v_exp_f32 v41, v41
    v_smfmac_f32_32x32x32_bf16 v[48:63], v[92:95], v[32:39], v14
    ds_read_b128 v[92:95], v11 offset:40672
    s_cmp_ge_u32 s10, 15
    s_cselect_b32 s64, s73, s72
    buffer_load_dwordx4 v[196:199], v10, s[52:55], s64 offen offset:1024 sc1
    v_exp_f32 v42, v42
    v_exp_f32 v43, v43
    v_exp_f32 v44, v44
    v_exp_f32 v45, v45
    v_exp_f32 v46, v46
    v_exp_f32 v47, v47
    v_exp_f32 v16, v16
    v_exp_f32 v17, v17
    s_waitcnt lgkmcnt(3)
    v_smfmac_f32_32x32x32_bf16 v[48:63], v[100:103], v[40:47], v14
    ds_read_b128 v[100:103], v6 offset:40672
    v_exp_f32 v18, v18
    v_exp_f32 v19, v19
    v_exp_f32 v20, v20
    v_mfma_f32_32x32x16_bf16 v[32:47], v[84:87], v[128:131], v[64:79]
    ds_read_b128 v[84:87], v4 offset:50944
    s_cmp_ge_u32 s10, 14
    s_cselect_b32 s64, s73, s72
    buffer_load_dwordx4 v[200:203], v10, s[52:55], s64 offen offset:2048 sc1
    v_exp_f32 v21, v21
    v_exp_f32 v22, v22
    v_exp_f32 v23, v23
    v_exp_f32 v24, v24
    v_exp_f32 v25, v25
    v_smfmac_f32_32x32x32_bf16 v[48:63], v[88:91], v[16:23], v14
    ds_read_b128 v[88:91], v11 offset:49920
    s_cmp_ge_u32 s10, 13
    s_cselect_b32 s64, s73, s72
    buffer_load_dwordx4 v[204:207], v10, s[52:55], s64 offen offset:3072 sc1
    v_exp_f32 v26, v26
    v_exp_f32 v27, v27
    v_exp_f32 v28, v28
    v_exp_f32 v29, v29
    v_exp_f32 v30, v30
    v_exp_f32 v31, v31
    v_exp_f32 v32, v32
    v_exp_f32 v33, v33
    s_waitcnt lgkmcnt(3)
    v_smfmac_f32_32x32x32_bf16 v[48:63], v[96:99], v[24:31], v14
    ds_read_b128 v[96:99], v6 offset:49920
    v_exp_f32 v34, v34
    v_exp_f32 v35, v35
    v_exp_f32 v36, v36
    v_mfma_f32_32x32x16_bf16 v[16:31], v[80:83], v[128:131], v[64:79]
    ds_read_b128 v[80:83], v4 offset:51968
    s_add_u32 s72, s72, 0x1000
    s_add_u32 s73, s73, 0x1000
    s_cmp_ge_u32 s10, 12
    s_cselect_b32 s64, s73, s72
    buffer_load_dwordx4 v[208:211], v10, s[52:55], s64 offen offset:0 sc1
    v_exp_f32 v37, v37
    v_exp_f32 v38, v38
    v_exp_f32 v39, v39
    v_exp_f32 v40, v40
    v_exp_f32 v41, v41
    v_smfmac_f32_32x32x32_bf16 v[48:63], v[92:95], v[32:39], v14
    ds_read_b128 v[92:95], v11 offset:50976
    s_cmp_ge_u32 s10, 11
    s_cselect_b32 s64, s73, s72
    buffer_load_dwordx4 v[212:215], v10, s[52:55], s64 offen offset:1024 sc1
    v_exp_f32 v42, v42
    v_exp_f32 v43, v43
    v_exp_f32 v44, v44
    v_exp_f32 v45, v45
    v_exp_f32 v46, v46
    v_exp_f32 v47, v47
    v_exp_f32 v16, v16
    v_exp_f32 v17, v17
    s_waitcnt lgkmcnt(3)
    v_smfmac_f32_32x32x32_bf16 v[48:63], v[100:103], v[40:47], v14
    ds_read_b128 v[100:103], v6 offset:50976
    v_exp_f32 v18, v18
    v_exp_f32 v19, v19
    v_exp_f32 v20, v20
    v_mfma_f32_32x32x16_bf16 v[32:47], v[84:87], v[128:131], v[64:79]
    ds_read_b128 v[84:87], v4 offset:52992
    s_cmp_ge_u32 s10, 10
    s_cselect_b32 s64, s73, s72
    buffer_load_dwordx4 v[216:219], v10, s[52:55], s64 offen offset:2048 sc1
    v_exp_f32 v21, v21
    v_exp_f32 v22, v22
    v_exp_f32 v23, v23
    v_exp_f32 v24, v24
    v_exp_f32 v25, v25
    v_smfmac_f32_32x32x32_bf16 v[48:63], v[88:91], v[16:23], v14
    ds_read_b128 v[88:91], v11 offset:52032
    s_cmp_ge_u32 s10, 9
    s_cselect_b32 s64, s73, s72
    buffer_load_dwordx4 v[220:223], v10, s[52:55], s64 offen offset:3072 sc1
    v_exp_f32 v26, v26
    v_exp_f32 v27, v27
    v_exp_f32 v28, v28
    v_exp_f32 v29, v29
    v_exp_f32 v30, v30
    v_exp_f32 v31, v31
    s_setprio 2
    v_exp_f32 v32, v32
    v_exp_f32 v33, v33
    s_waitcnt lgkmcnt(3)
    v_smfmac_f32_32x32x32_bf16 v[48:63], v[96:99], v[24:31], v14
    ds_read_b128 v[96:99], v6 offset:52032
    v_exp_f32 v34, v34
    v_exp_f32 v35, v35
    v_exp_f32 v36, v36
    v_mfma_f32_32x32x16_bf16 v[16:31], v[80:83], v[128:131], v[64:79]
    ds_read_b128 v[80:83], v4 offset:54016
    s_add_u32 s72, s72, 0x1000
    s_add_u32 s73, s73, 0x1000
    s_cmp_ge_u32 s10, 8
    s_cselect_b32 s64, s73, s72
    buffer_load_dwordx4 v[224:227], v10, s[52:55], s64 offen offset:0 sc1
    v_exp_f32 v37, v37
    v_exp_f32 v38, v38
    v_exp_f32 v39, v39
    v_exp_f32 v40, v40
    v_exp_f32 v41, v41
    v_smfmac_f32_32x32x32_bf16 v[48:63], v[92:95], v[32:39], v14
    ds_read_b128 v[92:95], v11 offset:53088
    s_cmp_ge_u32 s10, 7
    s_cselect_b32 s64, s73, s72
    buffer_load_dwordx4 v[228:231], v10, s[52:55], s64 offen offset:1024 sc1
    v_exp_f32 v42, v42
    v_exp_f32 v43, v43
    v_exp_f32 v44, v44
    v_exp_f32 v45, v45
    v_exp_f32 v46, v46
    v_exp_f32 v47, v47
    v_exp_f32 v16, v16
    v_exp_f32 v17, v17
    s_waitcnt lgkmcnt(3)
    v_smfmac_f32_32x32x32_bf16 v[48:63], v[100:103], v[40:47], v14
    ds_read_b128 v[100:103], v6 offset:53088
    v_exp_f32 v18, v18
    v_exp_f32 v19, v19
    v_exp_f32 v20, v20
    v_mfma_f32_32x32x16_bf16 v[32:47], v[84:87], v[128:131], v[64:79]
    ds_read_b128 v[84:87], v4 offset:55040
    s_cmp_ge_u32 s10, 6
    s_cselect_b32 s64, s73, s72
    buffer_load_dwordx4 v[232:235], v10, s[52:55], s64 offen offset:2048 sc1
    v_exp_f32 v21, v21
    v_exp_f32 v22, v22
    v_exp_f32 v23, v23
    v_exp_f32 v24, v24
    v_exp_f32 v25, v25
    v_smfmac_f32_32x32x32_bf16 v[48:63], v[88:91], v[16:23], v14
    ds_read_b128 v[88:91], v11 offset:54144
    s_cmp_ge_u32 s10, 5
    s_cselect_b32 s64, s73, s72
    buffer_load_dwordx4 v[236:239], v10, s[52:55], s64 offen offset:3072 sc1
    v_exp_f32 v26, v26
    v_exp_f32 v27, v27
    v_exp_f32 v28, v28
    v_exp_f32 v29, v29
    v_exp_f32 v30, v30
    v_exp_f32 v31, v31
    v_exp_f32 v32, v32
    v_exp_f32 v33, v33
    s_waitcnt lgkmcnt(3)
    v_smfmac_f32_32x32x32_bf16 v[48:63], v[96:99], v[24:31], v14
    ds_read_b128 v[96:99], v6 offset:54144
    v_exp_f32 v34, v34
    v_exp_f32 v35, v35
    v_exp_f32 v36, v36
    v_mfma_f32_32x32x16_bf16 v[16:31], v[80:83], v[128:131], v[64:79]
    ds_read_b128 v[80:83], v4 offset:56064
    s_add_u32 s72, s72, 0x1000
    s_add_u32 s73, s73, 0x1000
    s_cmp_ge_u32 s10, 4
    s_cselect_b32 s64, s73, s72
    buffer_load_dwordx4 v[240:243], v10, s[52:55], s64 offen offset:0 sc1
    v_exp_f32 v37, v37
    v_exp_f32 v38, v38
    v_exp_f32 v39, v39
    v_exp_f32 v40, v40
    v_exp_f32 v41, v41
    v_smfmac_f32_32x32x32_bf16 v[48:63], v[92:95], v[32:39], v14
    ds_read_b128 v[92:95], v11 offset:55200
    s_cmp_ge_u32 s10, 3
    s_cselect_b32 s64, s73, s72
    buffer_load_dwordx4 v[244:247], v10, s[52:55], s64 offen offset:1024 sc1
    v_exp_f32 v42, v42
    v_exp_f32 v43, v43
    v_exp_f32 v44, v44
    v_exp_f32 v45, v45
    v_exp_f32 v46, v46
    v_exp_f32 v47, v47
    v_exp_f32 v16, v16
    v_exp_f32 v17, v17
    s_waitcnt lgkmcnt(3)
    v_smfmac_f32_32x32x32_bf16 v[48:63], v[100:103], v[40:47], v14
    ds_read_b128 v[100:103], v6 offset:55200
    v_exp_f32 v18, v18
    v_exp_f32 v19, v19
    v_exp_f32 v20, v20
    v_mfma_f32_32x32x16_bf16 v[32:47], v[84:87], v[128:131], v[64:79]
    ds_read_b128 v[84:87], v4 offset:57088
    s_cmp_ge_u32 s10, 2
    s_cselect_b32 s64, s73, s72
    buffer_load_dwordx4 v[248:251], v10, s[52:55], s64 offen offset:2048 sc1
    v_exp_f32 v21, v21
    v_exp_f32 v22, v22
    v_exp_f32 v23, v23
    v_exp_f32 v24, v24
    v_exp_f32 v25, v25
    v_smfmac_f32_32x32x32_bf16 v[48:63], v[88:91], v[16:23], v14
    ds_read_b128 v[88:91], v11 offset:56256
    s_cmp_ge_u32 s10, 1
    s_cselect_b32 s64, s73, s72
    buffer_load_dwordx4 v[252:255], v10, s[52:55], s64 offen offset:3072 sc1
    v_exp_f32 v26, v26
    v_exp_f32 v27, v27
    v_exp_f32 v28, v28
    v_exp_f32 v29, v29
    v_exp_f32 v30, v30
    v_exp_f32 v31, v31
    s_setprio 1
    v_exp_f32 v32, v32
    v_exp_f32 v33, v33
    s_waitcnt lgkmcnt(3)
    v_smfmac_f32_32x32x32_bf16 v[48:63], v[96:99], v[24:31], v14
    ds_read_b128 v[96:99], v6 offset:56256
    v_exp_f32 v34, v34
    v_exp_f32 v35, v35
    v_exp_f32 v36, v36
    v_mfma_f32_32x32x16_bf16 v[16:31], v[80:83], v[128:131], v[64:79]
    v_exp_f32 v37, v37
    v_exp_f32 v38, v38
    v_exp_f32 v39, v39
    v_exp_f32 v40, v40
    v_exp_f32 v41, v41
    v_smfmac_f32_32x32x32_bf16 v[48:63], v[92:95], v[32:39], v14
    ds_read_b128 v[92:95], v11 offset:57312
    v_exp_f32 v42, v42
    v_exp_f32 v43, v43
    v_exp_f32 v44, v44
    v_exp_f32 v45, v45
    v_exp_f32 v46, v46
    v_exp_f32 v47, v47
    v_exp_f32 v16, v16
    v_exp_f32 v17, v17
    s_waitcnt lgkmcnt(2)
    v_smfmac_f32_32x32x32_bf16 v[48:63], v[100:103], v[40:47], v14
    ds_read_b128 v[100:103], v6 offset:57312
    v_exp_f32 v18, v18
    v_exp_f32 v19, v19
    v_exp_f32 v20, v20
    v_mfma_f32_32x32x16_bf16 v[32:47], v[84:87], v[128:131], v[64:79]
    v_exp_f32 v21, v21
    v_exp_f32 v22, v22
    v_exp_f32 v23, v23
    v_exp_f32 v24, v24
    v_exp_f32 v25, v25
    v_smfmac_f32_32x32x32_bf16 v[48:63], v[88:91], v[16:23], v14
    v_exp_f32 v26, v26
    v_exp_f32 v27, v27
    v_exp_f32 v28, v28
    v_exp_f32 v29, v29
    v_exp_f32 v30, v30
    v_exp_f32 v31, v31
    v_exp_f32 v32, v32
    v_exp_f32 v33, v33
    s_waitcnt lgkmcnt(1)
    v_smfmac_f32_32x32x32_bf16 v[48:63], v[96:99], v[24:31], v14
    v_exp_f32 v34, v34
    v_exp_f32 v35, v35
    v_exp_f32 v36, v36
    v_exp_f32 v37, v37
    v_exp_f32 v38, v38
    v_exp_f32 v39, v39
    v_exp_f32 v40, v40
    v_exp_f32 v41, v41
    v_smfmac_f32_32x32x32_bf16 v[48:63], v[92:95], v[32:39], v14
    v_exp_f32 v42, v42
    v_exp_f32 v43, v43
    v_exp_f32 v44, v44
    v_exp_f32 v45, v45
    v_exp_f32 v46, v46
    v_exp_f32 v47, v47
    s_waitcnt lgkmcnt(0)
    s_nop 0
    v_smfmac_f32_32x32x32_bf16 v[48:63], v[100:103], v[40:47], v14
    s_setprio 2
L_att_fin:
    s_nop 1
    v_bfe_u32 v80, v0, 4, 1
    v_lshrrev_b32 v81, 5, v0
    v_bfe_u32 v82, v0, 2, 2
    v_and_b32 v83, 3, v0
    v_lshl_add_u32 v90, v81, 2, v82
    v_lshlrev_b32 v90, 7, v90
    v_lshl_add_u32 v90, v80, 5, v90
    v_lshl_add_u32 v90, v83, 3, v90
    v_lshrrev_b32 v91, 1, v82
    v_lshl_add_u32 v90, v91, 6, v90
    s_lshr_b32 s64, s56, 1
    s_lshl_b32 s64, s64, 11
    v_add_u32 v84, s64, v90
    v_xor_b32 v87, 64, v84
    v_add_u32 v85, 0x10000, v84
    v_add_u32 v86, 0x20000, v84
    v_add_u32 v88, 0x10000, v87
    v_add_u32 v89, 0x20000, v87
    ds_read_b64_tr_b16 v[64:65], v85 offset:17664
    ds_read_b64_tr_b16 v[66:67], v85 offset:18688
    ds_read_b64_tr_b16 v[68:69], v88 offset:17664
    ds_read_b64_tr_b16 v[70:71], v88 offset:18688
    ds_read_b64_tr_b16 v[72:73], v85 offset:25856
    ds_read_b64_tr_b16 v[74:75], v85 offset:26880
    ds_read_b64_tr_b16 v[76:77], v88 offset:25856
    ds_read_b64_tr_b16 v[78:79], v88 offset:26880
    v_mov_b32 v7, v56
    v_mov_b32 v15, v56
    v_add_f32 v8, abs(v48), abs(v49)
    s_nop 0
    v_permlane32_swap_b32 v7, v15
    v_add_f32 v8, abs(v50), v8
    v_add_f32 v8, abs(v51), v8
    v_add_f32 v8, abs(v52), v8
    v_add_f32 v8, abs(v53), v8
    v_add_f32 v8, abs(v54), v8
    v_add_f32 v8, abs(v55), v8
    v_rcp_f32 v15, v7
    s_mov_b32 s64, 0x7b800000
    s_mov_b32 s65, 0x7f800000
    s_mov_b32 s66, 0x8800000
    v_cmp_nlt_f32 s[80:81], v7, s64
    v_cmp_nlt_f32 vcc, v8, s65
    v_cmp_ngt_f32 s[68:69], v7, s66
    v_mul_f32 v48, v48, v15
    v_mul_f32 v49, v49, v15
    v_mul_f32 v50, v50, v15
    v_mul_f32 v51, v51, v15
    v_mul_f32 v52, v52, v15
    v_mul_f32 v53, v53, v15
    v_mul_f32 v54, v54, v15
    v_mul_f32 v55, v55, v15
    s_or_b64 vcc, vcc, s[80:81]
    s_or_b64 vcc, vcc, s[68:69]
    s_cmp_eq_u32 s78, 0
    s_cselect_b64 s[80:81], vcc, 0
    s_cmp_lg_u64 s[80:81], 0
    s_cbranch_scc1 L_slow
    v_cvt_pk_bf16_f32 v132, v48, v49
    v_cvt_pk_bf16_f32 v133, v50, v51
    v_cvt_pk_bf16_f32 v134, v52, v53
    v_cvt_pk_bf16_f32 v135, v54, v55
    v_min_u32 v132, -2, v132
    v_min_u32 v133, -2, v133
    v_min_u32 v134, -2, v134
    v_min_u32 v135, -2, v135
    s_lshl_b32 s64, s60, 3
    s_add_u32 s67, s64, s56
    s_lshl_b32 s64, s67, 5
    s_add_u32 s67, s64, s59
    s_lshl_b32 s64, s67, 10
    s_add_u32 s69, s64, 0x660000
    buffer_store_dwordx4 v[132:135], v10, s[52:55], s69 offen sc1
    s_lshl_b32 s67, s67, 7
    s_add_u32 s67, s67, 0x20000
    ds_read_b64_tr_b16 v[48:49], v85 offset:34048
    ds_read_b64_tr_b16 v[50:51], v85 offset:35072
    ds_read_b64_tr_b16 v[52:53], v88 offset:34048
    ds_read_b64_tr_b16 v[54:55], v88 offset:35072
    s_waitcnt vmcnt(32) lgkmcnt(10)
    v_mfma_f32_32x32x16_bf16 v[16:31], v[64:67], v[144:147], 0
    ds_read_b64_tr_b16 v[56:57], v85 offset:1024
    ds_read_b64_tr_b16 v[58:59], v85 offset:2048
    s_waitcnt lgkmcnt(10)
    v_mfma_f32_32x32x16_bf16 v[32:47], v[68:71], v[144:147], 0
    ds_read_b64_tr_b16 v[60:61], v88 offset:1024
    ds_read_b64_tr_b16 v[62:63], v88 offset:2048
    v_lshrrev_b32 v90, 3, v0
    v_bfe_u32 v91, v0, 4, 2
    v_lshlrev_b32 v91, 1, v91
    v_and_b32 v93, 7, v0
    v_xor_b32 v91, v91, v93
    v_lshlrev_b32 v91, 4, v91
    v_lshl_add_u32 v90, v90, 10, v91
    s_lshl_b32 s64, s56, 13
    s_lshl_b32 s65, s60, 7
    s_add_u32 s64, s64, s65
    v_add_u32 v92, s64, v90
    s_waitcnt vmcnt(30) lgkmcnt(10)
    v_mfma_f32_32x32x16_bf16 v[16:31], v[72:75], v[148:151], v[16:31]
    ds_read_b64_tr_b16 v[64:65], v85 offset:9216
    ds_read_b64_tr_b16 v[66:67], v85 offset:10240
    s_waitcnt lgkmcnt(10)
    v_mfma_f32_32x32x16_bf16 v[32:47], v[76:79], v[148:151], v[32:47]
    ds_read_b64_tr_b16 v[68:69], v88 offset:9216
    ds_read_b64_tr_b16 v[70:71], v88 offset:10240
    v_and_b32 v100, 15, v0
    v_lshrrev_b32 v101, 4, v0
    v_lshlrev_b32 v90, 10, v100
    v_lshl_add_u32 v95, v101, 3, v90
    s_lshl_b32 s64, s59, 2
    s_and_b32 s65, s56, 3
    s_add_u32 s64, s64, s65
    s_lshl_b32 s64, s64, 14
    s_lshl_b32 s65, s60, 7
    s_add_u32 s64, s64, s65
    s_lshr_b32 s65, s56, 2
    s_lshl_b32 s65, s65, 6
    s_add_u32 s70, s64, s65
    buffer_load_dwordx2 v[96:97], v95, s[24:27], s70 offen offset:0
    buffer_load_dwordx2 v[98:99], v95, s[24:27], s70 offen offset:32
    s_waitcnt vmcnt(31) lgkmcnt(10)
    v_mfma_f32_32x32x16_bf16 v[16:31], v[48:51], v[152:155], v[16:31]
    s_waitcnt lgkmcnt(8)
    v_mfma_f32_32x32x16_bf16 v[32:47], v[52:55], v[152:155], v[32:47]
    v_and_b32 v90, 1, v101
    v_lshl_add_u32 v90, v90, 5, v100
    s_and_b32 s64, s56, 1
    s_lshl_b32 s64, s64, 4
    v_add_u32 v90, s64, v90
    v_lshlrev_b32 v90, 4, v90
    v_lshl_add_u32 v102, v81, 10, v90
    s_lshl_b32 s64, s59, 1
    s_bfe_u32 s65, s56, 0x10001
    s_add_u32 s64, s64, s65
    s_lshl_b32 s64, s64, 5
    s_lshr_b32 s65, s56, 2
    s_lshl_b32 s65, s65, 4
    s_add_u32 s71, s64, s65
    s_lshl_b32 s68, s71, 7
    s_add_u32 s68, s68, 0x20000
    s_waitcnt vmcnt(29) lgkmcnt(6)
    v_mfma_f32_32x32x16_bf16 v[16:31], v[56:59], v[156:159], v[16:31]
    s_waitcnt vmcnt(24)
    s_waitcnt lgkmcnt(0)
    s_barrier
    v_mfma_f32_32x32x16_bf16 v[32:47], v[60:63], v[156:159], v[32:47]
    ds_read_b64_tr_b16 v[72:73], v85 offset:42240
    ds_read_b64_tr_b16 v[74:75], v85 offset:43264
    ds_read_b64_tr_b16 v[76:77], v88 offset:42240
    ds_read_b64_tr_b16 v[78:79], v88 offset:43264
    ds_read_b64_tr_b16 v[48:49], v85 offset:50432
    ds_read_b64_tr_b16 v[50:51], v85 offset:51456
    ds_read_b64_tr_b16 v[52:53], v88 offset:50432
    ds_read_b64_tr_b16 v[54:55], v88 offset:51456
    s_add_u32 m0, s75, 0x8000
    s_add_u32 s74, s74, 0x4000
    s_cmp_eq_u32 s74, 0x70000
    s_cselect_b32 s74, 0, s74
    buffer_load_dwordx4 v12, s[44:47], s74 offen lds
    v_mfma_f32_32x32x16_bf16 v[16:31], v[64:67], v[160:163], v[16:31]
    ds_read_b64_tr_b16 v[56:57], v85 offset:58624
    ds_read_b64_tr_b16 v[58:59], v85 offset:59648
    s_add_u32 m0, s75, 0xa000
    s_add_u32 s74, s74, 0x4000
    s_cmp_eq_u32 s74, 0x70000
    s_cselect_b32 s74, 0, s74
    buffer_load_dwordx4 v12, s[44:47], s74 offen lds
    v_mfma_f32_32x32x16_bf16 v[32:47], v[68:71], v[160:163], v[32:47]
    ds_read_b64_tr_b16 v[60:61], v88 offset:58624
    ds_read_b64_tr_b16 v[62:63], v88 offset:59648
    s_waitcnt lgkmcnt(10)
    v_mfma_f32_32x32x16_bf16 v[16:31], v[72:75], v[164:167], v[16:31]
    ds_read_b64_tr_b16 v[64:65], v86 offset:1280
    ds_read_b64_tr_b16 v[66:67], v86 offset:2304
    s_add_u32 m0, s75, 0xc000
    s_add_u32 s74, s74, 0x4000
    s_cmp_eq_u32 s74, 0x70000
    s_cselect_b32 s74, 0, s74
    buffer_load_dwordx4 v12, s[44:47], s74 offen lds
    s_waitcnt lgkmcnt(10)
    v_mfma_f32_32x32x16_bf16 v[32:47], v[76:79], v[164:167], v[32:47]
    ds_read_b64_tr_b16 v[68:69], v89 offset:1280
    ds_read_b64_tr_b16 v[70:71], v89 offset:2304
    s_waitcnt lgkmcnt(10)
    v_mfma_f32_32x32x16_bf16 v[16:31], v[48:51], v[168:171], v[16:31]
    ds_read_b64_tr_b16 v[72:73], v86 offset:9472
    ds_read_b64_tr_b16 v[74:75], v86 offset:10496
    s_add_u32 m0, s75, 0xe000
    s_add_u32 s74, s74, 0x4000
    s_cmp_eq_u32 s74, 0x70000
    s_cselect_b32 s74, 0, s74
    buffer_load_dwordx4 v12, s[44:47], s74 offen lds
    s_waitcnt lgkmcnt(10)
    v_mfma_f32_32x32x16_bf16 v[32:47], v[52:55], v[168:171], v[32:47]
    ds_read_b64_tr_b16 v[76:77], v89 offset:9472
    ds_read_b64_tr_b16 v[78:79], v89 offset:10496
    v_and_b32 v103, 31, v0
    v_xor_b32 v90, v81, v100
    v_lshlrev_b32 v90, 4, v90
    v_lshl_add_u32 v103, v103, 8, v90
    s_lshr_b32 s65, s56, 1
    s_mov_b32 s64, 0x10400
    s_cmp_eq_u32 s65, 1
    s_cselect_b32 s64, 0x14500, s64
    s_cmp_eq_u32 s65, 2
    s_cselect_b32 s64, 0x18500, s64
    s_cmp_eq_u32 s65, 3
    s_cselect_b32 s64, 0x22500, s64
    s_and_b32 s65, s56, 1
    s_lshl_b32 s65, s65, 13
    s_add_u32 s64, s64, s65
    v_add_u32 v103, s64, v103
    s_waitcnt vmcnt(27) lgkmcnt(10)
    v_mfma_f32_32x32x16_bf16 v[16:31], v[56:59], v[172:175], v[16:31]
    ds_read_b64_tr_b16 v[48:49], v86 offset:17664
    ds_read_b64_tr_b16 v[50:51], v86 offset:18688
    s_add_u32 m0, s75, 0x14500
    s_add_u32 s74, s74, 0x4000
    s_cmp_eq_u32 s74, 0x70000
    s_cselect_b32 s74, 0, s74
    buffer_load_dwordx4 v12, s[44:47], s74 offen lds
    s_waitcnt lgkmcnt(10)
    v_mfma_f32_32x32x16_bf16 v[32:47], v[60:63], v[172:175], v[32:47]
    ds_read_b64_tr_b16 v[52:53], v89 offset:17664
    ds_read_b64_tr_b16 v[54:55], v89 offset:18688
    v_xor_b32 v136, 0, v103
    v_xor_b32 v137, 32, v103
    v_xor_b32 v138, 64, v103
    v_xor_b32 v139, 0x60, v103
    v_xor_b32 v140, 0x80, v103
    v_xor_b32 v141, 0xa0, v103
    v_xor_b32 v142, 0xc0, v103
    v_xor_b32 v143, 0xe0, v103
    s_waitcnt vmcnt(27) lgkmcnt(10)
    v_mfma_f32_32x32x16_bf16 v[16:31], v[64:67], v[176:179], v[16:31]
    ds_read_b64_tr_b16 v[56:57], v84 offset:0
    ds_read_b64_tr_b16 v[58:59], v84 offset:1024
    s_add_u32 m0, s75, 0x16500
    s_add_u32 s74, s74, 0x4000
    s_cmp_eq_u32 s74, 0x70000
    s_cselect_b32 s74, 0, s74
    buffer_load_dwordx4 v12, s[44:47], s74 offen lds
    s_waitcnt lgkmcnt(10)
    v_mfma_f32_32x32x16_bf16 v[32:47], v[68:71], v[176:179], v[32:47]
    ds_read_b64_tr_b16 v[60:61], v87 offset:0
    ds_read_b64_tr_b16 v[62:63], v87 offset:1024
    s_waitcnt vmcnt(27) lgkmcnt(10)
    v_mfma_f32_32x32x16_bf16 v[16:31], v[72:75], v[180:183], v[16:31]
    ds_read_b64_tr_b16 v[64:65], v84 offset:8192
    ds_read_b64_tr_b16 v[66:67], v84 offset:9216
    s_add_u32 m0, s75, 0x18500
    s_add_u32 s74, s74, 0x4000
    s_cmp_eq_u32 s74, 0x70000
    s_cselect_b32 s74, 0, s74
    buffer_load_dwordx4 v12, s[44:47], s74 offen lds
    s_waitcnt lgkmcnt(10)
    v_mfma_f32_32x32x16_bf16 v[32:47], v[76:79], v[180:183], v[32:47]
    ds_read_b64_tr_b16 v[68:69], v87 offset:8192
    ds_read_b64_tr_b16 v[70:71], v87 offset:9216
    s_waitcnt vmcnt(27) lgkmcnt(10)
    v_mfma_f32_32x32x16_bf16 v[16:31], v[48:51], v[184:187], v[16:31]
    ds_read_b64_tr_b16 v[72:73], v84 offset:16384
    ds_read_b64_tr_b16 v[74:75], v84 offset:17408
    s_add_u32 m0, s75, 0x10400
    s_add_u32 s74, s74, 0x4000
    s_cmp_eq_u32 s74, 0x70000
    s_cselect_b32 s74, 0, s74
    buffer_load_dwordx4 v12, s[44:47], s74 offen lds
    s_waitcnt lgkmcnt(10)
    v_mfma_f32_32x32x16_bf16 v[32:47], v[52:55], v[184:187], v[32:47]
    ds_read_b64_tr_b16 v[76:77], v87 offset:16384
    ds_read_b64_tr_b16 v[78:79], v87 offset:17408
    s_waitcnt vmcnt(27) lgkmcnt(10)
    v_mfma_f32_32x32x16_bf16 v[16:31], v[56:59], v[188:191], v[16:31]
    ds_read_b64_tr_b16 v[48:49], v84 offset:24576
    ds_read_b64_tr_b16 v[50:51], v84 offset:25600
    s_add_u32 m0, s75, 0x12400
    s_add_u32 s74, s74, 0x4000
    s_cmp_eq_u32 s74, 0x70000
    s_cselect_b32 s74, 0, s74
    buffer_load_dwordx4 v12, s[44:47], s74 offen lds
    s_waitcnt lgkmcnt(10)
    v_mfma_f32_32x32x16_bf16 v[32:47], v[60:63], v[188:191], v[32:47]
    ds_read_b64_tr_b16 v[52:53], v87 offset:24576
    ds_read_b64_tr_b16 v[54:55], v87 offset:25600
    v_and_b32 v91, 1, v101
    v_lshlrev_b32 v90, 4, v81
    v_lshl_add_u32 v90, v91, 2, v90
    v_add_u32 v90, v90, v82
    v_lshlrev_b32 v90, 7, v90
    v_lshl_add_u32 v90, v83, 3, v90
    v_lshrrev_b32 v93, 1, v82
    v_lshl_add_u32 v93, v91, 1, v93
    s_lshr_b32 s64, s56, 2
    s_lshl_b32 s65, s64, 1
    v_xor_b32 v93, s65, v93
    v_lshl_add_u32 v90, v93, 5, v90
    s_lshl_b32 s65, s64, 15
    v_add_u32 v4, s65, v90
    v_xor_b32 v5, 32, v4
    v_xor_b32 v6, 64, v4
    v_xor_b32 v7, 0x60, v4
    s_waitcnt vmcnt(27) lgkmcnt(10)
    v_mfma_f32_32x32x16_bf16 v[16:31], v[64:67], v[192:195], v[16:31]
    s_waitcnt lgkmcnt(8)
    v_mfma_f32_32x32x16_bf16 v[32:47], v[68:71], v[192:195], v[32:47]
    s_lshr_b32 s64, s56, 2
    s_lshl_b32 s65, s64, 3
    v_add_u32 v93, s65, v101
    v_xor_b32 v93, v93, v100
    v_lshlrev_b32 v93, 4, v93
    v_lshl_add_u32 v93, v100, 8, v93
    s_and_b32 s65, s56, 3
    s_lshl_b32 s65, s65, 12
    s_add_u32 s65, s65, 0x10400
    v_add_u32 v8, s65, v93
    v_xor_b32 v9, 64, v8
    s_lshl_b32 s64, s56, 11
    s_add_u32 s64, s64, 0x1c500
    v_add_u32 v14, s64, v10
    s_xor_b32 s65, s56, 4
    s_lshl_b32 s65, s65, 11
    s_add_u32 s65, s65, 0x1c500
    v_add_u32 v15, s65, v10
    s_waitcnt vmcnt(26) lgkmcnt(6)
    v_mfma_f32_32x32x16_bf16 v[16:31], v[72:75], v[196:199], v[16:31]
    s_waitcnt vmcnt(4)
    s_waitcnt lgkmcnt(0)
    s_barrier
    v_mfma_f32_32x32x16_bf16 v[32:47], v[76:79], v[196:199], v[32:47]
    ds_read_b64_tr_b16 v[56:57], v84 offset:32768
    ds_read_b64_tr_b16 v[58:59], v84 offset:33792
    ds_read_b64_tr_b16 v[60:61], v87 offset:32768
    ds_read_b64_tr_b16 v[62:63], v87 offset:33792
    ds_read_b64_tr_b16 v[64:65], v84 offset:40960
    ds_read_b64_tr_b16 v[66:67], v84 offset:41984
    ds_read_b64_tr_b16 v[68:69], v87 offset:40960
    ds_read_b64_tr_b16 v[70:71], v87 offset:41984
    s_add_u32 m0, s75, 0x1a500
    s_add_u32 s74, s74, 0x4000
    s_cmp_eq_u32 s74, 0x70000
    s_cselect_b32 s74, 0, s74
    buffer_load_dwordx4 v12, s[44:47], s74 offen lds
    v_mfma_f32_32x32x16_bf16 v[16:31], v[48:51], v[200:203], v[16:31]
    ds_read_b64_tr_b16 v[72:73], v84 offset:49152
    ds_read_b64_tr_b16 v[74:75], v84 offset:50176
    s_add_u32 m0, s75, 0x1c500
    s_add_u32 s74, s74, 0x4000
    s_cmp_eq_u32 s74, 0x70000
    s_cselect_b32 s74, 0, s74
    buffer_load_dwordx4 v12, s[44:47], s74 offen lds
    v_mfma_f32_32x32x16_bf16 v[32:47], v[52:55], v[200:203], v[32:47]
    ds_read_b64_tr_b16 v[76:77], v87 offset:49152
    ds_read_b64_tr_b16 v[78:79], v87 offset:50176
    s_waitcnt lgkmcnt(10)
    v_mfma_f32_32x32x16_bf16 v[16:31], v[56:59], v[204:207], v[16:31]
    ds_read_b64_tr_b16 v[48:49], v84 offset:57344
    ds_read_b64_tr_b16 v[50:51], v84 offset:58368
    s_add_u32 m0, s75, 0x1e500
    s_add_u32 s74, s74, 0x4000
    s_cmp_eq_u32 s74, 0x70000
    s_cselect_b32 s74, 0, s74
    buffer_load_dwordx4 v12, s[44:47], s74 offen lds
    s_waitcnt lgkmcnt(10)
    v_mfma_f32_32x32x16_bf16 v[32:47], v[60:63], v[204:207], v[32:47]
    ds_read_b64_tr_b16 v[52:53], v87 offset:57344
    ds_read_b64_tr_b16 v[54:55], v87 offset:58368
    s_waitcnt lgkmcnt(10)
    v_mfma_f32_32x32x16_bf16 v[16:31], v[64:67], v[208:211], v[16:31]
    ds_read_b64_tr_b16 v[56:57], v85 offset:17664
    ds_read_b64_tr_b16 v[58:59], v85 offset:18688
    s_add_u32 m0, s75, 0x20500
    s_add_u32 s74, s74, 0x4000
    s_cmp_eq_u32 s74, 0x70000
    s_cselect_b32 s74, 0, s74
    buffer_load_dwordx4 v12, s[44:47], s74 offen lds
    s_waitcnt lgkmcnt(10)
    v_mfma_f32_32x32x16_bf16 v[32:47], v[68:71], v[208:211], v[32:47]
    ds_read_b64_tr_b16 v[60:61], v88 offset:17664
    ds_read_b64_tr_b16 v[62:63], v88 offset:18688
    v_lshrrev_b32 v90, 1, v101
    s_lshr_b32 s64, s56, 2
    s_lshl_b32 s64, s64, 2
    v_add_u32 v90, s64, v90
    v_and_b32 v91, 7, v100
    v_xor_b32 v90, v90, v91
    v_lshlrev_b32 v90, 4, v90
    v_and_b32 v91, 1, v101
    v_lshl_add_u32 v90, v91, 3, v90
    v_lshl_add_u32 v90, v100, 7, v90
    s_and_b32 s64, s56, 3
    s_lshl_b32 s64, s64, 11
    s_add_u32 s64, s64, 0x20500
    v_add_u32 v1, s64, v90
    v_xor_b32 v2, 32, v1
    v_lshrrev_b32 v93, 3, v0
    v_and_b32 v91, 7, v0
    v_xor_b32 v90, v91, v93
    v_lshlrev_b32 v90, 4, v90
    v_lshl_add_u32 v90, v93, 7, v90
    s_add_u32 s64, s75, 0x20500
    v_add_u32 v3, s64, v90
    v_lshlrev_b32 v93, 10, v93
    v_lshl_add_u32 v11, v91, 4, v93
    s_lshl_b32 s64, s59, 3
    s_add_u32 s64, s64, s56
    s_lshl_b32 s64, s64, 13
    s_lshl_b32 s65, s60, 7
    s_add_u32 s67, s64, s65
    s_waitcnt lgkmcnt(10)
    v_mfma_f32_32x32x16_bf16 v[16:31], v[72:75], v[212:215], v[16:31]
    s_add_u32 m0, s75, 0
    s_mov_b32 s64, 0
    buffer_load_dwordx4 v92, s[32:35], s64 offen lds
    s_waitcnt lgkmcnt(8)
    v_mfma_f32_32x32x16_bf16 v[32:47], v[76:79], v[212:215], v[32:47]
    s_waitcnt lgkmcnt(6)
    v_mfma_f32_32x32x16_bf16 v[16:31], v[48:51], v[216:219], v[16:31]
    s_add_u32 m0, s75, 0x2000
    s_mov_b32 s64, 0x10000
    buffer_load_dwordx4 v92, s[32:35], s64 offen lds
    s_waitcnt vmcnt(5)
    s_waitcnt lgkmcnt(0)
    s_barrier
    v_mfma_f32_32x32x16_bf16 v[32:47], v[52:55], v[216:219], v[32:47]
    ds_read_b64_tr_b16 v[64:65], v85 offset:25856
    ds_read_b64_tr_b16 v[66:67], v85 offset:26880
    ds_read_b64_tr_b16 v[68:69], v88 offset:25856
    ds_read_b64_tr_b16 v[70:71], v88 offset:26880
    ds_read_b64_tr_b16 v[72:73], v85 offset:34048
    ds_read_b64_tr_b16 v[74:75], v85 offset:35072
    ds_read_b64_tr_b16 v[76:77], v88 offset:34048
    ds_read_b64_tr_b16 v[78:79], v88 offset:35072
    s_add_u32 m0, s75, 0x4000
    s_mov_b32 s64, 0x20000
    buffer_load_dwordx4 v92, s[32:35], s64 offen lds
    v_mfma_f32_32x32x16_bf16 v[16:31], v[56:59], v[220:223], v[16:31]
    ds_read_b64_tr_b16 v[48:49], v85 offset:1024
    ds_read_b64_tr_b16 v[50:51], v85 offset:2048
    s_add_u32 m0, s75, 0x6000
    s_mov_b32 s64, 0x30000
    buffer_load_dwordx4 v92, s[32:35], s64 offen lds
    v_mfma_f32_32x32x16_bf16 v[32:47], v[60:63], v[220:223], v[32:47]
    ds_read_b64_tr_b16 v[52:53], v88 offset:1024
    ds_read_b64_tr_b16 v[54:55], v88 offset:2048
    s_waitcnt lgkmcnt(10)
    v_mfma_f32_32x32x16_bf16 v[16:31], v[64:67], v[224:227], v[16:31]
    ds_read_b64_tr_b16 v[56:57], v85 offset:9216
    ds_read_b64_tr_b16 v[58:59], v85 offset:10240
    s_add_u32 m0, s75, 0x8000
    s_mov_b32 s64, 0x40000
    buffer_load_dwordx4 v92, s[32:35], s64 offen lds
    s_waitcnt lgkmcnt(10)
    v_mfma_f32_32x32x16_bf16 v[32:47], v[68:71], v[224:227], v[32:47]
    ds_read_b64_tr_b16 v[60:61], v88 offset:9216
    ds_read_b64_tr_b16 v[62:63], v88 offset:10240
    s_waitcnt lgkmcnt(10)
    v_mfma_f32_32x32x16_bf16 v[16:31], v[72:75], v[228:231], v[16:31]
    ds_read_b64_tr_b16 v[64:65], v85 offset:42240
    ds_read_b64_tr_b16 v[66:67], v85 offset:43264
    s_add_u32 m0, s75, 0xa000
    s_mov_b32 s64, 0x50000
    buffer_load_dwordx4 v92, s[32:35], s64 offen lds
    s_waitcnt lgkmcnt(10)
    v_mfma_f32_32x32x16_bf16 v[32:47], v[76:79], v[228:231], v[32:47]
    ds_read_b64_tr_b16 v[68:69], v88 offset:42240
    ds_read_b64_tr_b16 v[70:71], v88 offset:43264
    s_waitcnt lgkmcnt(10)
    v_mfma_f32_32x32x16_bf16 v[16:31], v[48:51], v[232:235], v[16:31]
    s_add_u32 m0, s75, 0xc000
    s_mov_b32 s64, 0x60000
    buffer_load_dwordx4 v92, s[32:35], s64 offen lds
    s_waitcnt lgkmcnt(8)
    v_mfma_f32_32x32x16_bf16 v[32:47], v[52:55], v[232:235], v[32:47]
    s_waitcnt lgkmcnt(6)
    v_mfma_f32_32x32x16_bf16 v[16:31], v[56:59], v[236:239], v[16:31]
    s_add_u32 m0, s75, 0xe000
    s_mov_b32 s64, 0x70000
    buffer_load_dwordx4 v92, s[32:35], s64 offen lds
    s_waitcnt vmcnt(8)
    s_waitcnt lgkmcnt(0)
    s_barrier
    v_mfma_f32_32x32x16_bf16 v[32:47], v[60:63], v[236:239], v[32:47]
    ds_read_b64_tr_b16 v[72:73], v85 offset:50432
    ds_read_b64_tr_b16 v[74:75], v85 offset:51456
    ds_read_b64_tr_b16 v[76:77], v85 offset:58624
    ds_read_b64_tr_b16 v[78:79], v85 offset:59648
    ds_read_b64_tr_b16 v[48:49], v86 offset:1280
    ds_read_b64_tr_b16 v[50:51], v86 offset:2304
    ds_read_b64_tr_b16 v[52:53], v88 offset:50432
    ds_read_b64_tr_b16 v[54:55], v88 offset:51456
    v_mfma_f32_32x32x16_bf16 v[16:31], v[64:67], v[240:243], v[16:31]
    ds_read_b64_tr_b16 v[56:57], v88 offset:58624
    ds_read_b64_tr_b16 v[58:59], v88 offset:59648
    v_mfma_f32_32x32x16_bf16 v[32:47], v[68:71], v[240:243], v[32:47]
    ds_read_b64_tr_b16 v[60:61], v89 offset:1280
    ds_read_b64_tr_b16 v[62:63], v89 offset:2304
    s_waitcnt lgkmcnt(10)
    v_mfma_f32_32x32x16_bf16 v[16:31], v[72:75], v[244:247], v[16:31]
    s_waitcnt lgkmcnt(8)
    v_mfma_f32_32x32x16_bf16 v[16:31], v[76:79], v[248:251], v[16:31]
    s_waitcnt lgkmcnt(6)
    v_mfma_f32_32x32x16_bf16 v[16:31], v[48:51], v[252:255], v[16:31]
    s_waitcnt lgkmcnt(4)
    v_mfma_f32_32x32x16_bf16 v[32:47], v[52:55], v[244:247], v[32:47]
    s_waitcnt lgkmcnt(2)
    v_mfma_f32_32x32x16_bf16 v[32:47], v[56:59], v[248:251], v[32:47]
    s_lshl_b32 s64, s71, 10
    s_add_u32 s72, s64, 0x660000
    buffer_load_dwordx4 v[104:107], v102, s[52:55], s72 offen offset:0 sc1
    s_waitcnt lgkmcnt(0)
    v_mfma_f32_32x32x16_bf16 v[32:47], v[60:63], v[252:255], v[32:47]
    buffer_load_dwordx4 v[108:111], v102, s[52:55], s72 offen offset:2048 sc1
    s_nop 1
    ds_write_b128 v136, v[16:19]
    ds_write_b128 v137, v[20:23]
    ds_write_b128 v138, v[24:27]
    ds_write_b128 v139, v[28:31]
    s_add_u32 s72, s72, 0x1000
    buffer_load_dwordx4 v[112:115], v102, s[52:55], s72 offen offset:0 sc1
    buffer_load_dwordx4 v[116:119], v102, s[52:55], s72 offen offset:2048 sc1
    s_add_u32 s72, s72, 0x1000
    buffer_load_dwordx4 v[120:123], v102, s[52:55], s72 offen offset:0 sc1
    buffer_load_dwordx4 v[124:127], v102, s[52:55], s72 offen offset:2048 sc1
    s_add_u32 s72, s72, 0x1000
    buffer_load_dwordx4 v[128:131], v102, s[52:55], s72 offen offset:0 sc1
    buffer_load_dwordx4 v[132:135], v102, s[52:55], s72 offen offset:2048 sc1
    ds_write_b128 v140, v[32:35]
    ds_write_b128 v141, v[36:39]
    ds_write_b128 v142, v[40:43]
    ds_write_b128 v143, v[44:47]
    s_waitcnt vmcnt(8)
    s_waitcnt lgkmcnt(0)
    s_barrier
    ds_read_b128 v[16:19], v8 offset:0
    ds_read_b128 v[20:23], v9 offset:0
    ds_read_b128 v[24:27], v8 offset:16640
    ds_read_b128 v[28:31], v9 offset:16640
    ds_read_b128 v[32:35], v8 offset:33024
    ds_read_b128 v[36:39], v9 offset:33024
    v_add_u32 v91, 0x12100, v8
    ds_read_b128 v[40:43], v91 offset:0
    v_add_u32 v91, 0x12100, v9
    ds_read_b128 v[44:47], v91 offset:0
    ds_read_b64_tr_b16 v[152:153], v6 offset:0
    ds_read_b64_tr_b16 v[154:155], v6 offset:1024
    ds_read_b64_tr_b16 v[156:157], v7 offset:0
    ds_read_b64_tr_b16 v[158:159], v7 offset:1024
    ds_read_b64_tr_b16 v[144:145], v4 offset:0
    ds_read_b64_tr_b16 v[146:147], v4 offset:1024
    ds_read_b64_tr_b16 v[148:149], v5 offset:0
    ds_read_b64_tr_b16 v[150:151], v5 offset:1024
    s_mov_b32 s64, 0xbfb8aa3b
    s_waitcnt lgkmcnt(13)
    v_add_f32 v16, v16, v24
    s_waitcnt lgkmcnt(9)
    v_add_f32 v32, v32, v40
    v_add_f32 v17, v17, v25
    v_add_f32 v33, v33, v41
    v_add_f32 v18, v18, v26
    v_add_f32 v34, v34, v42
    v_add_f32 v19, v19, v27
    v_add_f32 v35, v35, v43
    v_add_f32 v20, v20, v28
    s_waitcnt lgkmcnt(8)
    v_add_f32 v36, v36, v44
    v_add_f32 v21, v21, v29
    v_add_f32 v37, v37, v45
    v_add_f32 v22, v22, v30
    v_add_f32 v38, v38, v46
    v_add_f32 v23, v23, v31
    v_add_f32 v39, v39, v47
    ds_read_b64_tr_b16 v[168:169], v6 offset:4096
    ds_read_b64_tr_b16 v[170:171], v6 offset:5120
    ds_read_b64_tr_b16 v[172:173], v7 offset:4096
    ds_read_b64_tr_b16 v[174:175], v7 offset:5120
    ds_read_b64_tr_b16 v[160:161], v4 offset:4096
    ds_read_b64_tr_b16 v[162:163], v4 offset:5120
    ds_read_b64_tr_b16 v[164:165], v5 offset:4096
    ds_read_b64_tr_b16 v[166:167], v5 offset:5120
    v_add_f32 v16, v16, v32
    v_add_f32 v17, v17, v33
    v_add_f32 v18, v18, v34
    v_add_f32 v19, v19, v35
    v_add_f32 v20, v20, v36
    v_add_f32 v21, v21, v37
    v_add_f32 v22, v22, v38
    v_add_f32 v23, v23, v39
    v_mul_f32 v64, s64, v16
    v_mul_f32 v65, s64, v17
    v_mul_f32 v66, s64, v18
    v_mul_f32 v67, s64, v19
    v_mul_f32 v68, s64, v20
    v_mul_f32 v69, s64, v21
    v_mul_f32 v70, s64, v22
    v_mul_f32 v71, s64, v23
    ds_read_b64_tr_b16 v[184:185], v6 offset:8192
    ds_read_b64_tr_b16 v[186:187], v6 offset:9216
    ds_read_b64_tr_b16 v[188:189], v7 offset:8192
    ds_read_b64_tr_b16 v[190:191], v7 offset:9216
    ds_read_b64_tr_b16 v[176:177], v4 offset:8192
    ds_read_b64_tr_b16 v[178:179], v4 offset:9216
    ds_read_b64_tr_b16 v[180:181], v5 offset:8192
    ds_read_b64_tr_b16 v[182:183], v5 offset:9216
    s_waitcnt vmcnt(7)
    v_max3_u32 v91, v104, v105, v106
    s_waitcnt vmcnt(6)
    v_max3_u32 v91, v107, v108, v91
    v_max3_u32 v91, v109, v110, v91
    s_waitcnt vmcnt(5)
    v_max3_u32 v91, v111, v112, v91
    v_max3_u32 v91, v113, v114, v91
    s_waitcnt vmcnt(4)
    v_max3_u32 v91, v115, v116, v91
    v_max3_u32 v91, v117, v118, v91
    s_waitcnt vmcnt(3)
    v_max3_u32 v91, v119, v120, v91
    v_max3_u32 v91, v121, v122, v91
    s_waitcnt vmcnt(2)
    v_max3_u32 v91, v123, v124, v91
    v_max3_u32 v91, v125, v126, v91
    s_waitcnt vmcnt(1)
    v_max3_u32 v91, v127, v128, v91
    v_max3_u32 v91, v129, v130, v91
    s_waitcnt vmcnt(0)
    v_max3_u32 v91, v131, v132, v91
    v_max3_u32 v91, v133, v134, v91
    v_max_u32 v91, v135, v91
    v_cmp_eq_u32 vcc, -1, v91
    s_cbranch_vccz L_ook_58
    s_mov_b32 s79, 0x40000
L_oagain_59:
    s_sub_u32 s72, s72, 0x3000
    buffer_load_dwordx4 v[104:107], v102, s[52:55], s72 offen offset:0 sc1
    buffer_load_dwordx4 v[108:111], v102, s[52:55], s72 offen offset:2048 sc1
    s_add_u32 s72, s72, 0x1000
    buffer_load_dwordx4 v[112:115], v102, s[52:55], s72 offen offset:0 sc1
    buffer_load_dwordx4 v[116:119], v102, s[52:55], s72 offen offset:2048 sc1
    s_add_u32 s72, s72, 0x1000
    buffer_load_dwordx4 v[120:123], v102, s[52:55], s72 offen offset:0 sc1
    buffer_load_dwordx4 v[124:127], v102, s[52:55], s72 offen offset:2048 sc1
    s_add_u32 s72, s72, 0x1000
    buffer_load_dwordx4 v[128:131], v102, s[52:55], s72 offen offset:0 sc1
    buffer_load_dwordx4 v[132:135], v102, s[52:55], s72 offen offset:2048 sc1
    s_waitcnt vmcnt(0) lgkmcnt(0)
    v_max3_u32 v91, v104, v105, v106
    v_max3_u32 v91, v107, v108, v91
    v_max3_u32 v91, v109, v110, v91
    v_max3_u32 v91, v111, v112, v91
    v_max3_u32 v91, v113, v114, v91
    v_max3_u32 v91, v115, v116, v91
    v_max3_u32 v91, v117, v118, v91
    v_max3_u32 v91, v119, v120, v91
    v_max3_u32 v91, v121, v122, v91
    v_max3_u32 v91, v123, v124, v91
    v_max3_u32 v91, v125, v126, v91
    v_max3_u32 v91, v127, v128, v91
    v_max3_u32 v91, v129, v130, v91
    v_max3_u32 v91, v131, v132, v91
    v_max3_u32 v91, v133, v134, v91
    v_max_u32 v91, v135, v91
    v_cmp_eq_u32 vcc, -1, v91
    s_cbranch_vccz L_ook_58
    s_sub_u32 s79, s79, 1
    s_cmp_lg_u32 s79, 0
    s_cbranch_scc1 L_oagain_59
L_ook_58:
    s_waitcnt lgkmcnt(15)
    v_mfma_f32_16x16x32_bf16 v[32:35], v[152:155], v[104:107], 0
    v_mfma_f32_16x16x32_bf16 v[36:39], v[156:159], v[104:107], 0
    v_mfma_f32_16x16x32_bf16 v[24:27], v[144:147], v[104:107], 0
    v_mfma_f32_16x16x32_bf16 v[28:31], v[148:151], v[104:107], 0
    v_exp_f32 v64, v64
    v_exp_f32 v65, v65
    v_exp_f32 v66, v66
    v_exp_f32 v67, v67
    v_exp_f32 v68, v68
    v_exp_f32 v69, v69
    v_exp_f32 v70, v70
    v_exp_f32 v71, v71
    ds_read_b64_tr_b16 v[200:201], v6 offset:12288
    ds_read_b64_tr_b16 v[202:203], v6 offset:13312
    ds_read_b64_tr_b16 v[204:205], v7 offset:12288
    ds_read_b64_tr_b16 v[206:207], v7 offset:13312
    ds_read_b64_tr_b16 v[192:193], v4 offset:12288
    ds_read_b64_tr_b16 v[194:195], v4 offset:13312
    ds_read_b64_tr_b16 v[196:197], v5 offset:12288
    ds_read_b64_tr_b16 v[198:199], v5 offset:13312
    s_waitcnt lgkmcnt(15)
    v_mfma_f32_16x16x32_bf16 v[32:35], v[168:171], v[108:111], v[32:35]
    v_mfma_f32_16x16x32_bf16 v[36:39], v[172:175], v[108:111], v[36:39]
    v_mfma_f32_16x16x32_bf16 v[24:27], v[160:163], v[108:111], v[24:27]
    v_mfma_f32_16x16x32_bf16 v[28:31], v[164:167], v[108:111], v[28:31]
    v_add_f32 v64, 1.0, v64
    v_add_f32 v65, 1.0, v65
    v_add_f32 v66, 1.0, v66
    v_add_f32 v67, 1.0, v67
    v_add_f32 v68, 1.0, v68
    v_add_f32 v69, 1.0, v69
    v_add_f32 v70, 1.0, v70
    v_add_f32 v71, 1.0, v71
    ds_read_b64_tr_b16 v[216:217], v6 offset:16384
    ds_read_b64_tr_b16 v[218:219], v6 offset:17408
    ds_read_b64_tr_b16 v[220:221], v7 offset:16384
    ds_read_b64_tr_b16 v[222:223], v7 offset:17408
    ds_read_b64_tr_b16 v[208:209], v4 offset:16384
    ds_read_b64_tr_b16 v[210:211], v4 offset:17408
    ds_read_b64_tr_b16 v[212:213], v5 offset:16384
    ds_read_b64_tr_b16 v[214:215], v5 offset:17408
    s_waitcnt lgkmcnt(15)
    v_mfma_f32_16x16x32_bf16 v[32:35], v[184:187], v[112:115], v[32:35]
    v_mfma_f32_16x16x32_bf16 v[36:39], v[188:191], v[112:115], v[36:39]
    v_mfma_f32_16x16x32_bf16 v[24:27], v[176:179], v[112:115], v[24:27]
    v_mfma_f32_16x16x32_bf16 v[28:31], v[180:183], v[112:115], v[28:31]
    v_rcp_f32 v64, v64
    v_rcp_f32 v65, v65
    v_rcp_f32 v66, v66
    v_rcp_f32 v67, v67
    v_rcp_f32 v68, v68
    v_rcp_f32 v69, v69
    v_rcp_f32 v70, v70
    v_rcp_f32 v71, v71
    ds_read_b64_tr_b16 v[232:233], v6 offset:20480
    ds_read_b64_tr_b16 v[234:235], v6 offset:21504
    ds_read_b64_tr_b16 v[236:237], v7 offset:20480
    ds_read_b64_tr_b16 v[238:239], v7 offset:21504
    ds_read_b64_tr_b16 v[224:225], v4 offset:20480
    ds_read_b64_tr_b16 v[226:227], v4 offset:21504
    ds_read_b64_tr_b16 v[228:229], v5 offset:20480
    ds_read_b64_tr_b16 v[230:231], v5 offset:21504
    s_waitcnt lgkmcnt(15)
    v_mfma_f32_16x16x32_bf16 v[32:35], v[200:203], v[116:119], v[32:35]
    v_mfma_f32_16x16x32_bf16 v[36:39], v[204:207], v[116:119], v[36:39]
    v_mfma_f32_16x16x32_bf16 v[24:27], v[192:195], v[116:119], v[24:27]
    v_mfma_f32_16x16x32_bf16 v[28:31], v[196:199], v[116:119], v[28:31]
    v_mul_f32 v16, v16, v64
    v_mul_f32 v17, v17, v65
    v_mul_f32 v18, v18, v66
    v_mul_f32 v19, v19, v67
    v_mul_f32 v20, v20, v68
    v_mul_f32 v21, v21, v69
    v_mul_f32 v22, v22, v70
    v_mul_f32 v23, v23, v71
    ds_read_b64_tr_b16 v[248:249], v6 offset:24576
    ds_read_b64_tr_b16 v[250:251], v6 offset:25600
    ds_read_b64_tr_b16 v[252:253], v7 offset:24576
    ds_read_b64_tr_b16 v[254:255], v7 offset:25600
    ds_read_b64_tr_b16 v[240:241], v4 offset:24576
    ds_read_b64_tr_b16 v[242:243], v4 offset:25600
    ds_read_b64_tr_b16 v[244:245], v5 offset:24576
    ds_read_b64_tr_b16 v[246:247], v5 offset:25600
    s_waitcnt lgkmcnt(15)
    v_mfma_f32_16x16x32_bf16 v[32:35], v[216:219], v[120:123], v[32:35]
    v_mfma_f32_16x16x32_bf16 v[36:39], v[220:223], v[120:123], v[36:39]
    v_mfma_f32_16x16x32_bf16 v[24:27], v[208:211], v[120:123], v[24:27]
    v_mfma_f32_16x16x32_bf16 v[28:31], v[212:215], v[120:123], v[28:31]
    v_lshlrev_b32 v72, 16, v96
    v_and_b32 v73, s61, v96
    v_lshlrev_b32 v74, 16, v97
    v_and_b32 v75, s61, v97
    v_lshlrev_b32 v76, 16, v98
    v_and_b32 v77, s61, v98
    v_lshlrev_b32 v78, 16, v99
    v_and_b32 v79, s61, v99
    ds_read_b64_tr_b16 v[56:57], v6 offset:28672
    ds_read_b64_tr_b16 v[58:59], v6 offset:29696
    ds_read_b64_tr_b16 v[60:61], v7 offset:28672
    ds_read_b64_tr_b16 v[62:63], v7 offset:29696
    ds_read_b64_tr_b16 v[48:49], v4 offset:28672
    ds_read_b64_tr_b16 v[50:51], v4 offset:29696
    ds_read_b64_tr_b16 v[52:53], v5 offset:28672
    ds_read_b64_tr_b16 v[54:55], v5 offset:29696
    s_waitcnt lgkmcnt(15)
    v_mfma_f32_16x16x32_bf16 v[32:35], v[232:235], v[124:127], v[32:35]
    v_mfma_f32_16x16x32_bf16 v[36:39], v[236:239], v[124:127], v[36:39]
    v_mfma_f32_16x16x32_bf16 v[24:27], v[224:227], v[124:127], v[24:27]
    v_mfma_f32_16x16x32_bf16 v[28:31], v[228:231], v[124:127], v[28:31]
    s_waitcnt lgkmcnt(14)
    v_mfma_f32_16x16x32_bf16 v[32:35], v[248:251], v[128:131], v[32:35]
    s_waitcnt lgkmcnt(12)
    v_mfma_f32_16x16x32_bf16 v[36:39], v[252:255], v[128:131], v[36:39]
    s_waitcnt lgkmcnt(10)
    v_mfma_f32_16x16x32_bf16 v[24:27], v[240:243], v[128:131], v[24:27]
    s_waitcnt lgkmcnt(8)
    v_mfma_f32_16x16x32_bf16 v[28:31], v[244:247], v[128:131], v[28:31]
    s_waitcnt lgkmcnt(6)
    v_mfma_f32_16x16x32_bf16 v[32:35], v[56:59], v[132:135], v[32:35]
    s_waitcnt lgkmcnt(4)
    v_mfma_f32_16x16x32_bf16 v[36:39], v[60:63], v[132:135], v[36:39]
    s_waitcnt lgkmcnt(2)
    v_mfma_f32_16x16x32_bf16 v[24:27], v[48:51], v[132:135], v[24:27]
    s_waitcnt lgkmcnt(0)
    v_mfma_f32_16x16x32_bf16 v[28:31], v[52:55], v[132:135], v[28:31]
    s_nop 1
    ds_write_b128 v14, v[32:35] offset:0
    s_nop 0
    ds_write_b128 v14, v[36:39] offset:1024
    s_waitcnt lgkmcnt(0)
    s_barrier
    ds_read_b128 v[32:35], v15 offset:0
    ds_read_b128 v[36:39], v15 offset:1024
    s_waitcnt lgkmcnt(1)
    v_add_f32 v24, v24, v32
    v_add_f32 v25, v25, v33
    v_add_f32 v26, v26, v34
    v_add_f32 v27, v27, v35
    s_waitcnt lgkmcnt(0)
    v_add_f32 v28, v28, v36
    v_add_f32 v29, v29, v37
    v_add_f32 v30, v30, v38
    v_add_f32 v31, v31, v39
    v_fma_f32 v24, v24, v16, v72
    v_fma_f32 v25, v25, v17, v73
    v_fma_f32 v26, v26, v18, v74
    v_fma_f32 v27, v27, v19, v75
    v_fma_f32 v28, v28, v20, v76
    v_fma_f32 v29, v29, v21, v77
    v_fma_f32 v30, v30, v22, v78
    v_fma_f32 v31, v31, v23, v79
    v_cvt_pk_bf16_f32 v24, v24, v25
    v_cvt_pk_bf16_f32 v25, v26, v27
    v_cvt_pk_bf16_f32 v26, v28, v29
    v_cvt_pk_bf16_f32 v27, v30, v31
    ds_write_b64 v1, v[24:25]
    ds_write_b64 v2, v[26:27]
    s_waitcnt lgkmcnt(0)
    s_barrier
    ds_read_b128 v[28:31], v3
    s_waitcnt lgkmcnt(0)
    buffer_store_dwordx4 v[28:31], v11, s[48:51], s67 offen sc1
    s_or_b32 s64, s2, s56
    s_cmp_lg_u32 s64, 0
    s_cbranch_scc1 L_noep
    s_mov_b32 s64, 0
    v_mov_b32 v100, s63
    v_mov_b32 v101, 0
    s_mov_b64 exec, 1
    buffer_store_dword v100, v101, s[52:55], s64 offen sc1
    s_mov_b64 exec, -1
L_noep:
L_exit:
    s_endpgm
L_slow:
    s_waitcnt vmcnt(0) lgkmcnt(0)
    s_nop 15
    v_mov_b32 v7, 0xff800000
    s_lshl_b32 s66, s59, 16
    s_add_u32 s64, s66, 0x260000
    s_mov_b32 s67, 64
L_slow1:
    buffer_load_dwordx4 v[80:83], v10, s[52:55], s64 offen sc1
    s_waitcnt vmcnt(0)
    v_mfma_f32_32x32x16_bf16 v[16:31], v[80:83], v[128:131], 0
    s_nop 11
    v_max3_f32 v7, v16, v17, v7
    v_max3_f32 v7, v18, v19, v7
    v_max3_f32 v7, v20, v21, v7
    v_max3_f32 v7, v22, v23, v7
    v_max3_f32 v7, v24, v25, v7
    v_max3_f32 v7, v26, v27, v7
    v_max3_f32 v7, v28, v29, v7
    v_max3_f32 v7, v30, v31, v7
    s_add_u32 s64, s64, 0x400
    s_sub_u32 s67, s67, 1
    s_cmp_lg_u32 s67, 0
    s_cbranch_scc1 L_slow1
    v_mov_b32 v8, v7
    s_nop 1
    v_permlane32_swap_b32 v7, v8
    v_max_f32 v7, v7, v8
    v_sub_f32 v64, 0, v7
    v_mov_b32 v48, 0
    v_sub_f32 v65, 0, v7
    v_mov_b32 v49, 0
    v_sub_f32 v66, 0, v7
    v_mov_b32 v50, 0
    v_sub_f32 v67, 0, v7
    v_mov_b32 v51, 0
    v_sub_f32 v68, 0, v7
    v_mov_b32 v52, 0
    v_sub_f32 v69, 0, v7
    v_mov_b32 v53, 0
    v_sub_f32 v70, 0, v7
    v_mov_b32 v54, 0
    v_sub_f32 v71, 0, v7
    v_mov_b32 v55, 0
    v_sub_f32 v72, 0, v7
    v_mov_b32 v56, 0
    v_sub_f32 v73, 0, v7
    v_mov_b32 v57, 0
    v_sub_f32 v74, 0, v7
    v_mov_b32 v58, 0
    v_sub_f32 v75, 0, v7
    v_mov_b32 v59, 0
    v_sub_f32 v76, 0, v7
    v_mov_b32 v60, 0
    v_sub_f32 v77, 0, v7
    v_mov_b32 v61, 0
    v_sub_f32 v78, 0, v7
    v_mov_b32 v62, 0
    v_sub_f32 v79, 0, v7
    v_mov_b32 v63, 0
    v_mov_b32 v88, s62
    v_mov_b32 v96, s62
    v_mov_b32 v89, s62
    v_mov_b32 v97, s62
    v_mov_b32 v90, s62
    v_mov_b32 v98, s62
    v_mov_b32 v91, s62
    v_mov_b32 v99, s62
    v_and_b32 v7, 15, v0
    v_lshrrev_b32 v8, 5, v0
    v_lshl_add_u32 v8, v8, 4, v7
    v_lshlrev_b32 v8, 4, v8
    s_add_u32 s64, s66, 0x260000
    s_add_u32 s65, s66, 0x460000
    s_mov_b32 s67, 64
    s_mov_b32 s80, 0xffff
    s_mov_b32 s81, 0xffff
L_slow2:
    s_nop 15
    buffer_load_dwordx4 v[80:83], v10, s[52:55], s64 offen sc1
    s_mov_b64 exec, s[80:81]
    buffer_load_dwordx4 v[88:91], v8, s[52:55], s65 offen sc1
    buffer_load_dwordx4 v[96:99], v8, s[52:55], s65 offen offset:512 sc1
    s_mov_b64 exec, -1
    s_waitcnt vmcnt(0) lgkmcnt(0)
    v_mfma_f32_32x32x16_bf16 v[16:31], v[80:83], v[128:131], v[64:79]
    s_nop 11
    v_exp_f32 v16, v16
    v_exp_f32 v17, v17
    v_exp_f32 v18, v18
    v_exp_f32 v19, v19
    v_exp_f32 v20, v20
    v_exp_f32 v21, v21
    v_exp_f32 v22, v22
    v_exp_f32 v23, v23
    v_exp_f32 v24, v24
    v_exp_f32 v25, v25
    v_exp_f32 v26, v26
    v_exp_f32 v27, v27
    v_exp_f32 v28, v28
    v_exp_f32 v29, v29
    v_exp_f32 v30, v30
    v_exp_f32 v31, v31
    v_smfmac_f32_32x32x32_bf16 v[48:63], v[88:91], v[16:23], v14
    s_nop 0
    v_smfmac_f32_32x32x32_bf16 v[48:63], v[96:99], v[24:31], v14
    s_add_u32 s64, s64, 0x400
    s_add_u32 s65, s65, 0x400
    s_sub_u32 s67, s67, 1
    s_cmp_lg_u32 s67, 0
    s_cbranch_scc1 L_slow2
    s_mov_b32 s78, 1
    s_branch L_att_fin
L_code_end:
.if L_code_end - recurrent_scan__softmax_full_mha__glu_gated_swiglu__prompt_kernel < 32768 + 256
.error "the code prefetch assumes more than 32 KB of code"
.endif
.section .rodata,"a"
.p2align 6
.amdhsa_kernel recurrent_scan__softmax_full_mha__glu_gated_swiglu__prompt_kernel
  .amdhsa_next_free_vgpr 256
  .amdhsa_next_free_sgpr 102
  .amdhsa_accum_offset 256
  .amdhsa_group_segment_fixed_size 0
  .amdhsa_kernarg_size 80
  .amdhsa_user_sgpr_count 2
  .amdhsa_user_sgpr_kernarg_segment_ptr 1
  .amdhsa_system_sgpr_workgroup_id_x 1
.end_amdhsa_kernel
```
